```python
import torch

def _softmax(x, axis=-1):
    return torch.softmax(x, dim=axis)
def _gelu(x):
    return torch.nn.functional.gelu(x, approximate="tanh")
def _silu(x):
    return torch.nn.functional.silu(x)
def _sigmoid(x):
    return torch.sigmoid(x)
def _layernorm(x, axis=-1, eps=1e-5):
    m = x.mean(dim=axis, keepdim=True)
    v = x.var(dim=axis, keepdim=True, unbiased=False)
    return (x - m) / torch.sqrt(v + eps)
def _scatter_add(tgt, idx, src, axis=0):
    return tgt.clone().index_add_(axis, idx, src)
def _segment_sum(src, seg, n):
    out = torch.zeros((n,) + src.shape[1:], dtype=src.dtype)
    return out.index_add_(0, seg, src)
def _pad(x, pw):
    flat = tuple(v for pair in reversed(pw) for v in pair)
    return torch.nn.functional.pad(x, flat)

kernel_name = 'concat_heads__linear_attn_block__ssm_conv_s4d__prompt'

def setup_inputs():

    _w = (lambda a: (lambda t: t.to(torch.bfloat16) if t.is_floating_point() else t)(torch.as_tensor(a)))
    def _A_setup():
        B, S, D = 1, 2048, 512
        return {
            "x": _w((lambda *s: torch.randn(*s, dtype=torch.bfloat16) * 0.05)(B, S, D)),
            "wqkv": _w((lambda *s: torch.randn(*s, dtype=torch.bfloat16) * 0.4)(D, 3 * D)),
            "wo": _w((lambda *s: torch.randn(*s, dtype=torch.bfloat16) * 0.05)(D, D)),
        }
    _A_in = _A_setup()

    def _B_setup():
        Bsz, L, D, N = 1, 2048, 512, 128
        return {
            "u": _w((lambda *s: torch.randn(*s, dtype=torch.bfloat16) * 0.05)(Bsz, L, D)),
            "log_A_real": _w((lambda *s: torch.randn(*s, dtype=torch.bfloat16) * 6.4)(D, N) * 0.5),
            "A_imag": _w((lambda *s: torch.randn(*s, dtype=torch.bfloat16) * 0.05)(D, N) * 3.14),
            "C_real": _w((lambda *s: torch.randn(*s, dtype=torch.bfloat16) * 0.1)(D, N) / N ** 0.5),
            "C_imag": _w((lambda *s: torch.randn(*s, dtype=torch.bfloat16) * 0.1)(D, N) / N ** 0.5),
            "log_dt": _w((lambda *s: torch.randn(*s, dtype=torch.bfloat16) * 0.05)(D) * 0.5 - 4.0),
            "D_skip": _w((lambda *s: torch.randn(*s, dtype=torch.bfloat16) * 0.05)(D)),
        }
    _B_in = _B_setup()

    return {
        "A_x": _A_in["x"],
        "A_wqkv": _A_in["wqkv"],
        "A_wo": _A_in["wo"],
        "B_u": _B_in["u"],
        "B_log_A_real": _B_in["log_A_real"],
        "B_A_imag": _B_in["A_imag"],
        "B_C_real": _B_in["C_real"],
        "B_C_imag": _B_in["C_imag"],
        "B_log_dt": _B_in["log_dt"],
        "B_D_skip": _B_in["D_skip"],
    }

def reference(A_x, A_wqkv, A_wo, B_u, B_log_A_real, B_A_imag, B_C_real, B_C_imag, B_log_dt, B_D_skip):
    def _A_ref(x, wqkv, wo):
        B, S, D = x.shape
        H = 32; Dh = D // H
        qkv = (lambda x, *d: x.permute(*d))((x @ wqkv).reshape(B, S, 3, H, Dh), 2, 0, 3, 1, 4)
        q, k, v = qkv[0], qkv[1], qkv[2]
        phi = lambda t: torch.where(t > 0, t + 1, torch.exp(t)) + 1e-6
        pq, pk = phi(q), phi(k)
        kv = torch.einsum("bhsd,bhse->bhde", pk, v)
        z = torch.einsum("bhsd->bhd", pk)
        num = torch.einsum("bhqd,bhde->bhqe", pq, kv)
        den = torch.einsum("bhqd,bhd->bhq", pq, z)[..., None] + 1e-6
        o = num / den
        return (lambda x, *d: x.permute(*d))(o, 0, 2, 1, 3).reshape(B, S, D) @ wo

    def _B_ref(u, log_A_real, A_imag, C_real, C_imag, log_dt, D_skip):
        L = u.shape[1]
        dt = torch.exp(log_dt)
        A = -torch.exp(log_A_real) + 1j * A_imag
        C = (C_real + 1j * C_imag) * dt[:, None]
        pos = (lambda x, dt: x.to(dt))(torch.arange(L), log_dt.dtype)
        P = torch.exp((A * dt[:, None])[:, :, None] * pos[None, None, :])
        K = 2.0 * torch.einsum("dn,dnl->dl", C, P).real
        L2 = 2 * L
        u_t = (lambda x, *d: x.permute(*d))(u, 0, 2, 1)
        Kf = (lambda x, *a, **k: torch.fft.rfft(x.float(), *a, **k))(K, L2)
        Uf = (lambda x, *a, **k: torch.fft.rfft(x.float(), *a, **k))(u_t, L2)
        y = (lambda x, *a, **k: torch.fft.irfft(x, *a, **k).to(torch.bfloat16))(Uf * Kf[None, :, :], L2)[:, :, :L]
        y = (lambda x, *d: x.permute(*d))(y, 0, 2, 1)
        return y + u * D_skip[None, None, :]

    a = _A_ref(A_x, A_wqkv, A_wo)
    b = _B_ref(B_u, B_log_A_real, B_A_imag, B_C_real, B_C_imag, B_log_dt, B_D_skip)
    return torch.concatenate([a, b], axis=-1)
```

```asm
; @launch grid=(512,1,1) block=(256,1,1) lds=81920
.amdgcn_target "amdgcn-amd-amdhsa--gfx950"
.text
.globl concat_heads__linear_attn_block__ssm_conv_s4d__prompt_kernel
.p2align 8
.type concat_heads__linear_attn_block__ssm_conv_s4d__prompt_kernel,@function
concat_heads__linear_attn_block__ssm_conv_s4d__prompt_kernel:
    s_cmp_ge_u32 s2, 512
    s_cbranch_scc1 L_exit
    s_load_dwordx16 s[16:31], s[0:1], 0
    s_load_dwordx8 s[32:39], s[0:1], 64
    s_load_dwordx2 s[40:41], s[0:1], 96
    s_cmp_ge_u32 s2, 32
    s_cbranch_scc1 L_nocpf
    s_getpc_b64 s[4:5]
L_cpf_base:
    s_mov_b32 s6, L_code_end-L_cpf_base-4
    v_lshlrev_b32 v244, 7, v0
    v_add_u32 v245, 0x8000, v244
    v_min_u32 v244, s6, v244
    v_min_u32 v245, s6, v245
    v_and_b32 v244, -4, v244
    v_and_b32 v245, -4, v245
    global_load_dword v246, v244, s[4:5]
L_nocpf:
    s_cmp_ge_u32 s2, 448
    s_cbranch_scc1 L_gidle0
    s_cmp_ge_u32 s2, 256
    s_cbranch_scc1 L_g0
    v_lshrrev_b32 v1, 6, v0
    v_and_b32 v2, 63, v0
    s_nop 0
    v_readfirstlane_b32 s13, v1
L_B:
    s_and_b32 s3, s2, 7
    s_lshr_b32 s15, s2, 3
    s_and_b32 s5, s15, 15
    s_lshr_b32 s81, s15, 4
    s_lshl_b32 s80, s3, 6
    s_lshl_b32 s5, s5, 2
    s_add_u32 s80, s80, s5
    s_lshr_b32 s4, s13, 1
    s_add_u32 s4, s4, s80
    s_lshl_b32 s5, s81, 1
    s_add_u32 s4, s4, s5
    s_lshl_b32 s83, s2, 7
    s_add_u32 s83, s83, 0x210000
    v_lshlrev_b32 v202, 2, v2
    s_and_b32 s5, s13, 1
    s_lshl_b32 s6, s4, 8
    s_lshl_b32 s7, s5, 7
    s_add_u32 s6, s6, s7
    s_lshl_b32 s7, s4, 1
    v_lshlrev_b32 v3, 1, v2
    v_mov_b32 v4, 0
    v_add_u32 v3, s6, v3
    v_mov_b32 v5, s7
    s_waitcnt lgkmcnt(0)
    global_load_ushort v8, v3, s[24:25]
    global_load_ushort v9, v3, s[26:27]
    global_load_ushort v12, v5, s[32:33]
    global_load_ushort v10, v3, s[28:29]
    global_load_ushort v11, v3, s[30:31]
    global_load_ushort v13, v5, s[34:35]
    s_mov_b32 s52, s40
    s_mov_b32 s53, s41
    s_mov_b32 s54, 0x1000000
    s_mov_b32 s55, 0x00020000
    s_mov_b32 s56, s38
    s_mov_b32 s57, s39
    s_mov_b32 s58, 0x100
    s_mov_b32 s59, 0x00020000
    s_branch L_Bbody
L_g0:
    s_setprio 2
    v_lshrrev_b32 v1, 6, v0
    v_and_b32 v2, 63, v0
    s_nop 0
    v_readfirstlane_b32 s13, v1
    s_sub_u32 s2, s2, 256
    s_lshr_b32 s9, s2, 5
    s_mov_b32 s82, 0
    s_and_b32 s3, s2, 7
    s_lshr_b32 s4, s2, 3
    s_lshr_b32 s5, s3, 1
    s_and_b32 s6, s3, 1
    s_and_b32 s7, s4, 3
    s_lshl_b32 s8, s5, 2
    s_add_u32 s8, s8, s7
    s_lshl_b32 s10, s7, 1
    s_add_u32 s10, s10, s9
    s_and_b32 s10, s10, 7
    s_lshl_b32 s14, s6, 1
    s_add_u32 s14, s14, s9
    s_lshl_b32 s11, s14, 8
    s_lshl_b32 s42, s6, 2
    s_add_u32 s42, s42, s9
    s_sub_u32 s42, s42, 2
    s_lshl_b32 s43, s42, 7
    s_add_u32 s43, s43, 1024
    s_cmp_lt_u32 s9, 2
    s_cselect_b32 s14, s14, s42
    s_cselect_b32 s11, s11, s43
    s_movk_i32 s12, 128
    s_cselect_b32 s12, s12, 1024
    s_lshl_b32 s15, s8, 7
    s_lshl_b32 s42, s13, 5
    s_add_u32 s15, s15, s42
    s_lshl_b32 s15, s15, 10
    v_lshrrev_b32 v16, 3, v2
    v_lshlrev_b32 v16, 10, v16
    v_add_u32 v16, s15, v16
    v_and_b32 v17, 7, v2
    v_lshrrev_b32 v18, 4, v2
    v_xor_b32 v19, v17, v18
    v_lshl_add_u32 v4, v19, 4, v16
    v_xor_b32 v19, 4, v19
    v_lshl_add_u32 v5, v19, 4, v16
    v_add_u32 v5, 7168, v5
    v_add_u32 v6, 14336, v4
    v_add_u32 v7, 14336, v5
    s_lshl_b32 s42, s13, 3
    v_add_u32 v16, s42, v18
    s_movk_i32 s42, 3072
    v_mul_lo_u32 v16, v16, s42
    v_add_u32 v16, s11, v16
    v_bfe_u32 v17, v2, 2, 2
    v_xor_b32 v17, v17, v18
    v_lshrrev_b32 v19, 1, v17
    v_mul_lo_u32 v19, v19, s12
    v_add_u32 v16, v16, v19
    v_and_b32 v17, 1, v17
    v_lshl_add_u32 v16, v17, 6, v16
    v_and_b32 v17, 3, v2
    v_lshl_add_u32 v8, v17, 4, v16
    v_add_u32 v9, 11264, v8
    s_lshl_b32 s60, s13, 12
    s_lshl_b32 s61, s13, 11
    s_add_u32 s61, s61, 49152
    s_lshl_b32 s62, s10, 1
    s_waitcnt lgkmcnt(0)
    s_mov_b32 s44, s16
    s_mov_b32 s45, s17
    s_mov_b32 s46, 0x200000
    s_mov_b32 s47, 0x00020000
    s_mov_b32 s48, s18
    s_mov_b32 s49, s19
    s_mov_b32 s50, 0x180000
    s_mov_b32 s51, 0x00020000
    s_lshr_b32 s42, s13, 1
    s_and_b32 s43, s13, 1
    s_lshl_b32 s42, s42, 6
    v_and_b32 v16, 31, v2
    v_add_u32 v17, s42, v16
    v_lshlrev_b32 v17, 7, v17
    v_bfe_u32 v18, v2, 1, 3
    v_lshrrev_b32 v19, 5, v2
    v_xor_b32 v18, v18, v19
    v_xor_b32 v19, 0, v18
    v_lshl_add_u32 v10, v19, 4, v17
    v_xor_b32 v19, 2, v18
    v_lshl_add_u32 v11, v19, 4, v17
    v_xor_b32 v19, 4, v18
    v_lshl_add_u32 v12, v19, 4, v17
    v_xor_b32 v19, 6, v18
    v_lshl_add_u32 v13, v19, 4, v17
    v_bfe_u32 v16, v2, 2, 2
    v_lshrrev_b32 v17, 5, v2
    v_lshl_add_u32 v17, v17, 3, v16
    v_lshlrev_b32 v17, 8, v17
    v_xor_b32 v18, s43, v16
    v_lshl_add_u32 v17, v18, 6, v17
    v_bfe_u32 v18, v2, 4, 1
    v_lshl_add_u32 v17, v18, 5, v17
    v_and_b32 v18, 3, v2
    v_lshl_add_u32 v17, v18, 3, v17
    v_add_u32 v14, 49152, v17
    v_xor_b32 v15, 128, v14
    s_mov_b32 s64, 0x358637bd
    v_mov_b32 v21, 0
    s_add_u32 s63, s10, 0
    s_and_b32 s63, s63, 7
    s_lshl_b32 s63, s63, 7
    s_add_u32 m0, s60, 0
    s_nop 0
    buffer_load_dwordx4 v4, s[44:47], s63 offen offset:0 lds
    s_add_u32 s63, s10, 0
    s_and_b32 s63, s63, 7
    s_lshl_b32 s63, s63, 7
    s_add_u32 m0, s60, 0
    s_nop 0
    buffer_load_dwordx4 v5, s[44:47], s63 offen offset:1024 lds
    s_add_u32 s63, s10, 0
    s_and_b32 s63, s63, 7
    s_lshl_b32 s63, s63, 7
    s_add_u32 m0, s60, 0
    s_nop 0
    buffer_load_dwordx4 v6, s[44:47], s63 offen offset:2048 lds
    s_add_u32 s63, s10, 0
    s_and_b32 s63, s63, 7
    s_lshl_b32 s63, s63, 7
    s_add_u32 m0, s60, 0
    s_nop 0
    buffer_load_dwordx4 v7, s[44:47], s63 offen offset:3072 lds
    s_add_u32 s63, s62, 0
    s_and_b32 s63, s63, 15
    s_mul_i32 s63, s63, 98304
    s_add_u32 m0, s61, 0
    s_nop 0
    buffer_load_dwordx4 v8, s[48:51], s63 offen offset:0 lds
    s_add_u32 s63, s62, 0
    s_and_b32 s63, s63, 15
    s_mul_i32 s63, s63, 98304
    s_add_u32 m0, s61, 0
    s_nop 0
    buffer_load_dwordx4 v9, s[48:51], s63 offen offset:1024 lds
    s_add_u32 s63, s62, 1
    s_and_b32 s63, s63, 15
    s_mul_i32 s63, s63, 98304
    s_add_u32 m0, s61, 8192
    s_nop 0
    buffer_load_dwordx4 v8, s[48:51], s63 offen offset:0 lds
    s_add_u32 s63, s62, 1
    s_and_b32 s63, s63, 15
    s_mul_i32 s63, s63, 98304
    s_add_u32 m0, s61, 8192
    s_nop 0
    buffer_load_dwordx4 v9, s[48:51], s63 offen offset:1024 lds
    s_add_u32 s63, s10, 1
    s_and_b32 s63, s63, 7
    s_lshl_b32 s63, s63, 7
    s_add_u32 m0, s60, 16384
    s_nop 0
    buffer_load_dwordx4 v4, s[44:47], s63 offen offset:0 lds
    s_add_u32 s63, s10, 1
    s_and_b32 s63, s63, 7
    s_lshl_b32 s63, s63, 7
    s_add_u32 m0, s60, 16384
    s_nop 0
    buffer_load_dwordx4 v5, s[44:47], s63 offen offset:1024 lds
    s_add_u32 s63, s10, 1
    s_and_b32 s63, s63, 7
    s_lshl_b32 s63, s63, 7
    s_add_u32 m0, s60, 16384
    s_nop 0
    buffer_load_dwordx4 v6, s[44:47], s63 offen offset:2048 lds
    s_add_u32 s63, s10, 1
    s_and_b32 s63, s63, 7
    s_lshl_b32 s63, s63, 7
    s_add_u32 m0, s60, 16384
    s_nop 0
    buffer_load_dwordx4 v7, s[44:47], s63 offen offset:3072 lds
    s_add_u32 s63, s62, 2
    s_and_b32 s63, s63, 15
    s_mul_i32 s63, s63, 98304
    s_add_u32 m0, s61, 16384
    s_nop 0
    buffer_load_dwordx4 v8, s[48:51], s63 offen offset:0 lds
    s_add_u32 s63, s62, 2
    s_and_b32 s63, s63, 15
    s_mul_i32 s63, s63, 98304
    s_add_u32 m0, s61, 16384
    s_nop 0
    buffer_load_dwordx4 v9, s[48:51], s63 offen offset:1024 lds
    s_add_u32 s63, s62, 3
    s_and_b32 s63, s63, 15
    s_mul_i32 s63, s63, 98304
    s_add_u32 m0, s61, 24576
    s_nop 0
    buffer_load_dwordx4 v8, s[48:51], s63 offen offset:0 lds
    s_add_u32 s63, s62, 3
    s_and_b32 s63, s63, 15
    s_mul_i32 s63, s63, 98304
    s_add_u32 m0, s61, 24576
    s_nop 0
    buffer_load_dwordx4 v9, s[48:51], s63 offen offset:1024 lds
    s_mov_b32 s52, s40
    s_mov_b32 s53, s41
    s_mov_b32 s54, 0x1000000
    s_mov_b32 s55, 0x00020000
    s_mov_b32 s56, s38
    s_mov_b32 s57, s39
    s_mov_b32 s58, 0x100
    s_mov_b32 s59, 0x00020000
    s_cmp_lt_u32 s9, 2
    s_cbranch_scc1 L_q0
    s_branch L_kv0
L_Bbody:
    s_waitcnt vmcnt(0)
L_cpf2_w:
    s_mov_b32 s8, 0x3fb8aa3b
    v_lshlrev_b32 v8, 16, v8
    v_lshlrev_b32 v12, 16, v12
    v_mul_f32 v8, s8, v8
    v_mul_f32 v12, s8, v12
    v_exp_f32 v8, v8
    v_exp_f32 v12, v12
    v_lshlrev_b32 v9, 16, v9
    v_lshlrev_b32 v10, 16, v10
    v_lshlrev_b32 v11, 16, v11
    v_lshlrev_b32 v13, 16, v13
    v_cvt_pk_bf16_f32 v8, v8, v12
    v_and_b32 v12, 0xffff0000, v8
    v_lshlrev_b32 v8, 16, v8
    v_mul_f32 v8, v8, v12
    v_mul_f32 v8, 0xbfb8aa3b, v8
    v_mul_f32 v9, v9, v12
    v_mul_f32 v9, 0.15915494309189535, v9
    v_fract_f32 v9, v9
    v_mul_f32 v10, v10, v12
    v_mul_f32 v11, v11, v12
    v_add_f32 v10, v10, v10
    v_add_f32 v11, v11, v11
    s_lshl_b32 s9, s13, 10
    s_add_u32 s9, s9, 0
    v_lshlrev_b32 v5, 2, v2
    v_add_u32 v5, s9, v5
    ds_write_b32 v5, v8
    ds_write_b32 v5, v9 offset:256
    ds_write_b32 v5, v10 offset:512
    ds_write_b32 v5, v11 offset:768
    v_lshrrev_b32 v6, 4, v2
    v_lshlrev_b32 v6, 6, v6
    v_add_u32 v6, s9, v6
    v_and_b32 v7, 15, v2
    v_cvt_f32_u32 v14, v7
    v_cmp_eq_u32 vcc, 0, v2
    s_cmp_eq_u32 s5, 0
    s_cselect_b64 s[10:11], vcc, 0
    v_cndmask_b32 v13, 0, v13, s[10:11]
    s_waitcnt lgkmcnt(0)
    ds_read_b128 v[16:19], v6 offset:0
    ds_read_b128 v[20:23], v6 offset:16
    ds_read_b128 v[32:35], v6 offset:256
    ds_read_b128 v[36:39], v6 offset:272
    ds_read_b128 v[48:51], v6 offset:512
    ds_read_b128 v[52:55], v6 offset:528
    ds_read_b128 v[64:67], v6 offset:768
    ds_read_b128 v[68:71], v6 offset:784
    s_waitcnt lgkmcnt(0)
    s_setreg_imm32_b32 hwreg(HW_REG_MODE, 9, 1), 0
    v_mul_f32 v184, v16, v14
    v_mul_f32 v196, v18, v14
    v_mul_f32 v185, v17, v14
    v_mul_f32 v197, v19, v14
    v_mul_f32 v186, v32, v14
    v_mul_f32 v198, v34, v14
    v_mul_f32 v187, v33, v14
    v_mul_f32 v199, v35, v14
    v_exp_f32 v184, v184
    v_exp_f32 v196, v196
    v_exp_f32 v185, v185
    v_exp_f32 v197, v197
    v_cos_f32 v176, v186
    v_cos_f32 v188, v198
    v_cos_f32 v177, v187
    v_cos_f32 v189, v199
    v_sin_f32 v178, v186
    v_sin_f32 v190, v198
    v_sin_f32 v179, v187
    v_sin_f32 v191, v199
    v_mul_f32 v176, v176, v184
    v_mul_f32 v188, v188, v196
    v_mul_f32 v177, v177, v185
    v_mul_f32 v189, v189, v197
    v_mul_f32 v178, v178, v184
    v_mul_f32 v190, v190, v196
    v_mul_f32 v179, v179, v185
    v_mul_f32 v191, v191, v197
    v_cvt_pk_bf16_f32 v136, v176, v177
    v_cvt_pk_bf16_f32 v138, v188, v189
    v_cvt_pk_bf16_f32 v137, v178, v179
    v_cvt_pk_bf16_f32 v139, v190, v191
    v_mul_f32 v184, v178, v178
    v_mul_f32 v196, v190, v190
    v_mul_f32 v185, v179, v179
    v_mul_f32 v197, v191, v191
    v_mul_f32 v178, v176, v178 mul:2
    v_mul_f32 v190, v188, v190 mul:2
    v_mul_f32 v179, v177, v179 mul:2
    v_mul_f32 v191, v189, v191 mul:2
    v_fma_f32 v176, v176, v176, -v184
    v_fma_f32 v188, v188, v188, -v196
    v_fma_f32 v177, v177, v177, -v185
    v_fma_f32 v189, v189, v189, -v197
    v_cvt_pk_bf16_f32 v140, v176, v177
    v_cvt_pk_bf16_f32 v142, v188, v189
    v_cvt_pk_bf16_f32 v141, v178, v179
    v_cvt_pk_bf16_f32 v143, v190, v191
    v_mul_f32 v184, v178, v178
    v_mul_f32 v196, v190, v190
    v_mul_f32 v185, v179, v179
    v_mul_f32 v197, v191, v191
    v_mul_f32 v178, v176, v178 mul:2
    v_mul_f32 v190, v188, v190 mul:2
    v_mul_f32 v179, v177, v179 mul:2
    v_mul_f32 v191, v189, v191 mul:2
    v_fma_f32 v176, v176, v176, -v184
    v_fma_f32 v188, v188, v188, -v196
    v_fma_f32 v177, v177, v177, -v185
    v_fma_f32 v189, v189, v189, -v197
    v_cvt_pk_bf16_f32 v144, v176, v177
    v_cvt_pk_bf16_f32 v146, v188, v189
    v_cvt_pk_bf16_f32 v145, v178, v179
    v_cvt_pk_bf16_f32 v147, v190, v191
    v_mul_f32 v184, v178, v178
    v_mul_f32 v196, v190, v190
    v_mul_f32 v185, v179, v179
    v_mul_f32 v197, v191, v191
    v_mul_f32 v178, v176, v178 mul:2
    v_mul_f32 v190, v188, v190 mul:2
    v_mul_f32 v179, v177, v179 mul:2
    v_mul_f32 v191, v189, v191 mul:2
    v_fma_f32 v176, v176, v176, -v184
    v_fma_f32 v188, v188, v188, -v196
    v_fma_f32 v177, v177, v177, -v185
    v_fma_f32 v189, v189, v189, -v197
    v_cvt_pk_bf16_f32 v148, v176, v177
    v_cvt_pk_bf16_f32 v150, v188, v189
    v_cvt_pk_bf16_f32 v149, v178, v179
    v_cvt_pk_bf16_f32 v151, v190, v191
    v_mul_f32 v184, v178, v178
    v_mul_f32 v196, v190, v190
    v_mul_f32 v185, v179, v179
    v_mul_f32 v197, v191, v191
    v_mul_f32 v178, v176, v178 mul:2
    v_mul_f32 v190, v188, v190 mul:2
    v_mul_f32 v179, v177, v179 mul:2
    v_mul_f32 v191, v189, v191 mul:2
    v_fma_f32 v176, v176, v176, -v184
    v_fma_f32 v188, v188, v188, -v196
    v_fma_f32 v177, v177, v177, -v185
    v_fma_f32 v189, v189, v189, -v197
    v_cvt_pk_bf16_f32 v152, v176, v177
    v_cvt_pk_bf16_f32 v154, v188, v189
    v_cvt_pk_bf16_f32 v153, v178, v179
    v_cvt_pk_bf16_f32 v155, v190, v191
    v_mul_f32 v184, v64, v178
    v_mul_f32 v196, v66, v190
    v_mul_f32 v185, v65, v179
    v_mul_f32 v197, v67, v191
    v_mul_f32 v186, v64, v176
    v_mul_f32 v198, v66, v188
    v_mul_f32 v187, v65, v177
    v_mul_f32 v199, v67, v189
    v_fma_f32 v180, v48, v176, -v184
    v_fma_f32 v192, v50, v188, -v196
    v_fma_f32 v181, v49, v177, -v185
    v_fma_f32 v193, v51, v189, -v197
    v_fma_f32 v182, -v48, v178, -v186
    v_fma_f32 v194, -v50, v190, -v198
    v_fma_f32 v183, -v49, v179, -v187
    v_fma_f32 v195, -v51, v191, -v199
    v_cvt_pk_bf16_f32 v156, v180, v181
    v_cvt_pk_bf16_f32 v158, v192, v193
    v_cvt_pk_bf16_f32 v157, v182, v183
    v_cvt_pk_bf16_f32 v159, v194, v195
    v_mul_f32 v184, v182, v178
    v_mul_f32 v196, v194, v190
    v_mul_f32 v185, v183, v179
    v_mul_f32 v197, v195, v191
    v_mul_f32 v186, v180, v178
    v_mul_f32 v198, v192, v190
    v_mul_f32 v187, v181, v179
    v_mul_f32 v199, v193, v191
    v_fma_f32 v180, v180, v176, v184
    v_fma_f32 v192, v192, v188, v196
    v_fma_f32 v181, v181, v177, v185
    v_fma_f32 v193, v193, v189, v197
    v_fma_f32 v182, v182, v176, -v186
    v_fma_f32 v194, v194, v188, -v198
    v_fma_f32 v183, v183, v177, -v187
    v_fma_f32 v195, v195, v189, -v199
    v_cvt_pk_bf16_f32 v160, v180, v181
    v_cvt_pk_bf16_f32 v162, v192, v193
    v_cvt_pk_bf16_f32 v161, v182, v183
    v_cvt_pk_bf16_f32 v163, v194, v195
    v_mul_f32 v184, v178, v178
    v_mul_f32 v196, v190, v190
    v_mul_f32 v185, v179, v179
    v_mul_f32 v197, v191, v191
    v_mul_f32 v178, v176, v178 mul:2
    v_mul_f32 v190, v188, v190 mul:2
    v_mul_f32 v179, v177, v179 mul:2
    v_mul_f32 v191, v189, v191 mul:2
    v_fma_f32 v176, v176, v176, -v184
    v_fma_f32 v188, v188, v188, -v196
    v_fma_f32 v177, v177, v177, -v185
    v_fma_f32 v189, v189, v189, -v197
    v_mul_f32 v184, v182, v178
    v_mul_f32 v196, v194, v190
    v_mul_f32 v185, v183, v179
    v_mul_f32 v197, v195, v191
    v_mul_f32 v186, v180, v178
    v_mul_f32 v198, v192, v190
    v_mul_f32 v187, v181, v179
    v_mul_f32 v199, v193, v191
    v_fma_f32 v180, v180, v176, v184
    v_fma_f32 v192, v192, v188, v196
    v_fma_f32 v181, v181, v177, v185
    v_fma_f32 v193, v193, v189, v197
    v_fma_f32 v182, v182, v176, -v186
    v_fma_f32 v194, v194, v188, -v198
    v_fma_f32 v183, v183, v177, -v187
    v_fma_f32 v195, v195, v189, -v199
    v_cvt_pk_bf16_f32 v164, v180, v181
    v_cvt_pk_bf16_f32 v166, v192, v193
    v_cvt_pk_bf16_f32 v165, v182, v183
    v_cvt_pk_bf16_f32 v167, v194, v195
    v_mul_f32 v184, v178, v178
    v_mul_f32 v196, v190, v190
    v_mul_f32 v185, v179, v179
    v_mul_f32 v197, v191, v191
    v_mul_f32 v178, v176, v178 mul:2
    v_mul_f32 v190, v188, v190 mul:2
    v_mul_f32 v179, v177, v179 mul:2
    v_mul_f32 v191, v189, v191 mul:2
    v_fma_f32 v176, v176, v176, -v184
    v_fma_f32 v188, v188, v188, -v196
    v_fma_f32 v177, v177, v177, -v185
    v_fma_f32 v189, v189, v189, -v197
    v_mul_f32 v184, v182, v178
    v_mul_f32 v196, v194, v190
    v_mul_f32 v185, v183, v179
    v_mul_f32 v197, v195, v191
    v_mul_f32 v186, v180, v178
    v_mul_f32 v198, v192, v190
    v_mul_f32 v187, v181, v179
    v_mul_f32 v199, v193, v191
    v_fma_f32 v180, v180, v176, v184
    v_fma_f32 v192, v192, v188, v196
    v_fma_f32 v181, v181, v177, v185
    v_fma_f32 v193, v193, v189, v197
    v_fma_f32 v182, v182, v176, -v186
    v_fma_f32 v194, v194, v188, -v198
    v_fma_f32 v183, v183, v177, -v187
    v_fma_f32 v195, v195, v189, -v199
    v_cvt_pk_bf16_f32 v168, v180, v181
    v_cvt_pk_bf16_f32 v170, v192, v193
    v_cvt_pk_bf16_f32 v169, v182, v183
    v_cvt_pk_bf16_f32 v171, v194, v195
    v_mfma_f32_16x16x32_bf16 v[80:83], v[136:139], v[156:159], 0
    v_mfma_f32_16x16x32_bf16 v[84:87], v[140:143], v[160:163], 0
    v_mfma_f32_16x16x32_bf16 v[88:91], v[144:147], v[164:167], 0
    v_mfma_f32_16x16x32_bf16 v[92:95], v[148:151], v[168:171], 0
    v_mfma_f32_16x16x32_bf16 v[96:99], v[152:155], v[168:171], 0
    buffer_load_dword v200, v4, s[56:59], 0 offen sc1
    s_mov_b32 s12, 3
    v_add_u32 v6, 32, v6
L_kloop:
    s_waitcnt lgkmcnt(0)
    v_mul_f32 v184, v20, v14
    v_mul_f32 v196, v22, v14
    v_mul_f32 v185, v21, v14
    v_mul_f32 v197, v23, v14
    v_mul_f32 v186, v36, v14
    v_mul_f32 v198, v38, v14
    v_mul_f32 v187, v37, v14
    v_mul_f32 v199, v39, v14
    v_exp_f32 v184, v184
    v_exp_f32 v196, v196
    ds_read_b128 v[20:23], v6
    ds_read_b128 v[36:39], v6 offset:256
    v_exp_f32 v185, v185
    v_exp_f32 v197, v197
    v_cos_f32 v176, v186
    v_cos_f32 v188, v198
    v_cos_f32 v177, v187
    v_cos_f32 v189, v199
    v_sin_f32 v178, v186
    v_sin_f32 v190, v198
    v_sin_f32 v179, v187
    v_sin_f32 v191, v199
    v_mul_f32 v176, v176, v184
    v_mul_f32 v188, v188, v196
    v_mul_f32 v177, v177, v185
    v_mul_f32 v189, v189, v197
    v_mul_f32 v178, v178, v184
    v_mul_f32 v190, v190, v196
    v_mul_f32 v179, v179, v185
    v_mul_f32 v191, v191, v197
    v_cvt_pk_bf16_f32 v136, v176, v177
    v_cvt_pk_bf16_f32 v138, v188, v189
    v_cvt_pk_bf16_f32 v137, v178, v179
    v_cvt_pk_bf16_f32 v139, v190, v191
    v_mul_f32 v184, v178, v178
    v_mul_f32 v196, v190, v190
    v_mul_f32 v185, v179, v179
    v_mul_f32 v197, v191, v191
    v_mul_f32 v178, v176, v178 mul:2
    v_mul_f32 v190, v188, v190 mul:2
    v_mul_f32 v179, v177, v179 mul:2
    v_mul_f32 v191, v189, v191 mul:2
    v_fma_f32 v176, v176, v176, -v184
    v_fma_f32 v188, v188, v188, -v196
    v_fma_f32 v177, v177, v177, -v185
    v_fma_f32 v189, v189, v189, -v197
    v_cvt_pk_bf16_f32 v140, v176, v177
    v_cvt_pk_bf16_f32 v142, v188, v189
    v_cvt_pk_bf16_f32 v141, v178, v179
    v_cvt_pk_bf16_f32 v143, v190, v191
    v_mul_f32 v184, v178, v178
    v_mul_f32 v196, v190, v190
    v_mul_f32 v185, v179, v179
    v_mul_f32 v197, v191, v191
    v_mul_f32 v178, v176, v178 mul:2
    v_mul_f32 v190, v188, v190 mul:2
    v_mul_f32 v179, v177, v179 mul:2
    v_mul_f32 v191, v189, v191 mul:2
    v_fma_f32 v176, v176, v176, -v184
    v_fma_f32 v188, v188, v188, -v196
    v_fma_f32 v177, v177, v177, -v185
    v_fma_f32 v189, v189, v189, -v197
    v_cvt_pk_bf16_f32 v144, v176, v177
    v_cvt_pk_bf16_f32 v146, v188, v189
    v_cvt_pk_bf16_f32 v145, v178, v179
    v_cvt_pk_bf16_f32 v147, v190, v191
    v_mul_f32 v184, v178, v178
    v_mul_f32 v196, v190, v190
    v_mul_f32 v185, v179, v179
    v_mul_f32 v197, v191, v191
    v_mul_f32 v178, v176, v178 mul:2
    v_mul_f32 v190, v188, v190 mul:2
    v_mul_f32 v179, v177, v179 mul:2
    v_mul_f32 v191, v189, v191 mul:2
    v_fma_f32 v176, v176, v176, -v184
    v_fma_f32 v188, v188, v188, -v196
    v_fma_f32 v177, v177, v177, -v185
    v_fma_f32 v189, v189, v189, -v197
    v_cvt_pk_bf16_f32 v148, v176, v177
    v_cvt_pk_bf16_f32 v150, v188, v189
    v_cvt_pk_bf16_f32 v149, v178, v179
    v_cvt_pk_bf16_f32 v151, v190, v191
    v_mul_f32 v184, v178, v178
    v_mul_f32 v196, v190, v190
    v_mul_f32 v185, v179, v179
    v_mul_f32 v197, v191, v191
    v_mul_f32 v178, v176, v178 mul:2
    v_mul_f32 v190, v188, v190 mul:2
    v_mul_f32 v179, v177, v179 mul:2
    v_mul_f32 v191, v189, v191 mul:2
    v_fma_f32 v176, v176, v176, -v184
    v_fma_f32 v188, v188, v188, -v196
    v_fma_f32 v177, v177, v177, -v185
    v_fma_f32 v189, v189, v189, -v197
    v_cvt_pk_bf16_f32 v152, v176, v177
    v_cvt_pk_bf16_f32 v154, v188, v189
    v_cvt_pk_bf16_f32 v153, v178, v179
    v_cvt_pk_bf16_f32 v155, v190, v191
    v_mul_f32 v184, v68, v178
    v_mul_f32 v196, v70, v190
    v_mul_f32 v185, v69, v179
    v_mul_f32 v197, v71, v191
    v_mul_f32 v186, v68, v176
    v_mul_f32 v198, v70, v188
    v_mul_f32 v187, v69, v177
    v_mul_f32 v199, v71, v189
    v_fma_f32 v180, v52, v176, -v184
    v_fma_f32 v192, v54, v188, -v196
    v_fma_f32 v181, v53, v177, -v185
    v_fma_f32 v193, v55, v189, -v197
    v_fma_f32 v182, -v52, v178, -v186
    v_fma_f32 v194, -v54, v190, -v198
    v_fma_f32 v183, -v53, v179, -v187
    v_fma_f32 v195, -v55, v191, -v199
    v_cvt_pk_bf16_f32 v156, v180, v181
    v_cvt_pk_bf16_f32 v158, v192, v193
    ds_read_b128 v[52:55], v6 offset:512
    ds_read_b128 v[68:71], v6 offset:768
    v_add_u32 v6, 16, v6
    v_cvt_pk_bf16_f32 v157, v182, v183
    v_cvt_pk_bf16_f32 v159, v194, v195
    v_mul_f32 v184, v182, v178
    v_mul_f32 v196, v194, v190
    v_mul_f32 v185, v183, v179
    v_mul_f32 v197, v195, v191
    v_mul_f32 v186, v180, v178
    v_mul_f32 v198, v192, v190
    v_mul_f32 v187, v181, v179
    v_mul_f32 v199, v193, v191
    v_fma_f32 v180, v180, v176, v184
    v_fma_f32 v192, v192, v188, v196
    v_fma_f32 v181, v181, v177, v185
    v_fma_f32 v193, v193, v189, v197
    v_fma_f32 v182, v182, v176, -v186
    v_fma_f32 v194, v194, v188, -v198
    v_fma_f32 v183, v183, v177, -v187
    v_fma_f32 v195, v195, v189, -v199
    v_cvt_pk_bf16_f32 v160, v180, v181
    v_cvt_pk_bf16_f32 v162, v192, v193
    v_cvt_pk_bf16_f32 v161, v182, v183
    v_cvt_pk_bf16_f32 v163, v194, v195
    v_mul_f32 v184, v178, v178
    v_mul_f32 v196, v190, v190
    v_mul_f32 v185, v179, v179
    v_mul_f32 v197, v191, v191
    v_mul_f32 v178, v176, v178 mul:2
    v_mul_f32 v190, v188, v190 mul:2
    v_mul_f32 v179, v177, v179 mul:2
    v_mul_f32 v191, v189, v191 mul:2
    v_fma_f32 v176, v176, v176, -v184
    v_fma_f32 v188, v188, v188, -v196
    v_fma_f32 v177, v177, v177, -v185
    v_fma_f32 v189, v189, v189, -v197
    v_mul_f32 v184, v182, v178
    v_mul_f32 v196, v194, v190
    v_mul_f32 v185, v183, v179
    v_mul_f32 v197, v195, v191
    v_mul_f32 v186, v180, v178
    v_mul_f32 v198, v192, v190
    v_mul_f32 v187, v181, v179
    v_mul_f32 v199, v193, v191
    v_fma_f32 v180, v180, v176, v184
    v_fma_f32 v192, v192, v188, v196
    v_fma_f32 v181, v181, v177, v185
    v_fma_f32 v193, v193, v189, v197
    v_fma_f32 v182, v182, v176, -v186
    v_fma_f32 v194, v194, v188, -v198
    v_fma_f32 v183, v183, v177, -v187
    v_fma_f32 v195, v195, v189, -v199
    v_cvt_pk_bf16_f32 v164, v180, v181
    v_cvt_pk_bf16_f32 v166, v192, v193
    v_cvt_pk_bf16_f32 v165, v182, v183
    v_cvt_pk_bf16_f32 v167, v194, v195
    v_mul_f32 v184, v178, v178
    v_mul_f32 v196, v190, v190
    v_mul_f32 v185, v179, v179
    v_mul_f32 v197, v191, v191
    v_mul_f32 v178, v176, v178 mul:2
    v_mul_f32 v190, v188, v190 mul:2
    v_mul_f32 v179, v177, v179 mul:2
    v_mul_f32 v191, v189, v191 mul:2
    v_fma_f32 v176, v176, v176, -v184
    v_fma_f32 v188, v188, v188, -v196
    v_fma_f32 v177, v177, v177, -v185
    v_fma_f32 v189, v189, v189, -v197
    v_mul_f32 v184, v182, v178
    v_mul_f32 v196, v194, v190
    v_mul_f32 v185, v183, v179
    v_mul_f32 v197, v195, v191
    v_mul_f32 v186, v180, v178
    v_mul_f32 v198, v192, v190
    v_mul_f32 v187, v181, v179
    v_mul_f32 v199, v193, v191
    v_fma_f32 v180, v180, v176, v184
    v_fma_f32 v192, v192, v188, v196
    v_fma_f32 v181, v181, v177, v185
    v_fma_f32 v193, v193, v189, v197
    v_fma_f32 v182, v182, v176, -v186
    v_fma_f32 v194, v194, v188, -v198
    v_fma_f32 v183, v183, v177, -v187
    v_fma_f32 v195, v195, v189, -v199
    v_cvt_pk_bf16_f32 v168, v180, v181
    v_cvt_pk_bf16_f32 v170, v192, v193
    v_cvt_pk_bf16_f32 v169, v182, v183
    v_cvt_pk_bf16_f32 v171, v194, v195
    v_mfma_f32_16x16x32_bf16 v[80:83], v[136:139], v[156:159], v[80:83]
    v_mfma_f32_16x16x32_bf16 v[84:87], v[140:143], v[160:163], v[84:87]
    v_mfma_f32_16x16x32_bf16 v[88:91], v[144:147], v[164:167], v[88:91]
    v_mfma_f32_16x16x32_bf16 v[92:95], v[148:151], v[168:171], v[92:95]
    v_mfma_f32_16x16x32_bf16 v[96:99], v[152:155], v[168:171], v[96:99]
    s_sub_u32 s12, s12, 1
    s_cmp_lg_u32 s12, 0
    s_cbranch_scc1 L_kloop
    s_waitcnt lgkmcnt(0)
    s_mul_i32 s9, s13, 3072
    s_add_u32 s9, s9, 4112
    v_lshlrev_b32 v9, 6, v7
    v_lshrrev_b32 v10, 4, v2
    v_lshl_add_u32 v9, v10, 4, v9
    v_add_u32 v9, s9, v9
    v_mov_b32 v10, s9
    v_add_u32 v11, -4, v10
    v_lshlrev_b32 v3, 4, v2
    s_and_b32 s8, s13, 2
    s_mul_i32 s8, s8, 3072
    s_mul_i32 s9, s5, 1536
    s_add_u32 s8, s8, s9
    s_add_u32 s8, s8, 4096
    v_add_u32 v5, s8, v3
    s_mul_i32 s10, s4, 3072
    s_add_u32 s10, s10, s9
    s_add_u32 s10, s10, 0x300000
    v_add_f32 v80, v80, v13
    ds_write_b128 v9, v[80:83]
    s_mov_b32 exec_lo, 0xff00ff00
    s_mov_b32 exec_hi, 0xff00ff00
    ds_write_b128 v9, v[84:87] offset:512
    ds_write_b128 v9, v[88:91] offset:1024
    ds_write_b128 v9, v[92:95] offset:1536
    s_mov_b32 exec_lo, 0
    s_mov_b32 exec_hi, 0x8000
    ds_write_b32 v10, v96 offset:2560
    ds_write_b32 v11, v4
    s_mov_b64 exec, -1
    s_waitcnt lgkmcnt(0)
    s_barrier
    ds_read_b128 v[16:19], v5
    ds_read_b128 v[20:23], v5 offset:3072
    ds_read_b128 v[24:27], v5 offset:1024
    ds_read_b128 v[28:31], v5 offset:4096
    s_waitcnt lgkmcnt(2)
    v_add_f32 v16, v16, v20
    v_add_f32 v17, v17, v21
    v_add_f32 v18, v18, v22
    v_add_f32 v19, v19, v23
    buffer_store_dwordx4 v[16:19], v3, s[52:55], s10 offen sc1
    s_waitcnt lgkmcnt(0)
    v_add_f32 v24, v24, v28
    v_add_f32 v25, v25, v29
    v_add_f32 v26, v26, v30
    v_add_f32 v27, v27, v31
    s_mov_b32 exec_hi, 0
    buffer_store_dwordx4 v[24:27], v3, s[52:55], s10 offen offset:1024 sc1
    s_mov_b64 exec, -1
    s_add_u32 s8, s80, s13
    s_mul_i32 s9, s13, 17696
    s_mul_i32 s10, s8, 3072
    s_add_u32 s10, s10, 0x300000
    s_mul_i32 s12, s8, 4224
    s_add_u32 s12, s12, 0x600080
    s_sub_u32 s14, s12, 4
    s_lshl_b32 s60, s2, 7
    s_add_u32 s60, s60, 0x210000
    s_xor_b32 s61, s2, 128
    s_lshl_b32 s61, s61, 7
    s_add_u32 s61, s61, 0x210020
    s_mov_b32 s44, s36
    s_mov_b32 s45, s37
    s_mov_b32 s46, 0x400000
    s_mov_b32 s47, 0x00020000
    v_mov_b32 v201, 0
    v_lshlrev_b32 v202, 2, v2
    v_and_b32 v8, 15, v2
    v_lshrrev_b32 v9, 4, v2
    v_and_b32 v10, 1, v2
    v_lshrrev_b32 v11, 1, v8
    s_movk_i32 s15, 4224
    v_mul_lo_u32 v12, v10, s15
    v_lshlrev_b32 v13, 3, v11
    v_sub_u32 v12, v12, v13
    v_lshl_add_u32 v12, v9, 4, v12
    s_add_u32 s15, s9, 56
    v_add_u32 v4, s15, v12
    s_movk_i32 s15, -4640
    v_mul_lo_u32 v12, v10, s15
    v_lshl_add_u32 v12, v11, 6, v12
    v_lshl_add_u32 v12, v9, 4, v12
    s_add_u32 s15, s9, 13152
    v_add_u32 v5, s15, v12
    v_lshlrev_b32 v12, 6, v11
    v_lshl_add_u32 v12, v10, 2, v12
    v_lshl_add_u32 v12, v9, 4, v12
    v_add_u32 v6, s9, v12
    v_add_u32 v7, 1024, v6
    v_add_u32 v12, s9, v3
    s_add_u32 s15, s9, 16
    v_lshlrev_b32 v8, 2, v2
    v_sub_u32 v8, 2300, v8
    v_add_u32 v8, s15, v8
    v_lshlrev_b32 v9, 3, v2
    v_sub_u32 v9, 2040, v9
    v_add_u32 v9, s15, v9
    v_lshlrev_b32 v10, 4, v2
    v_sub_u32 v10, 1516, v10
    v_add_u32 v10, s15, v10
    v_lshlrev_b32 v11, 5, v2
    v_sub_u32 v11, 2012, v11
    v_add_u32 v11, s15, v11
    s_mov_b32 s6, 0xaaaaaaaa
    s_mov_b32 s7, 0xaaaaaaaa
    s_mov_b32 s4, 0x80000000
    s_mov_b32 s5, 0
    s_mov_b32 s43, 0
    s_branch L_mc2
L_mp1:
    s_sleep 4
    buffer_load_dword v200, v201, s[56:59], 0 offen sc1
    s_add_u32 s43, s43, 1
L_mc2:
    s_waitcnt vmcnt(0)
    v_readfirstlane_b32 s42, v200
    s_nop 3
    s_lshr_b32 s65, s43, 16
    s_or_b32 s42, s42, s65
    s_cmp_eq_u32 s42, 0
    s_cbranch_scc1 L_mp1
L_mx3:
    s_barrier
    v_mov_b32 v16, 0
    v_mov_b32 v17, 0
    v_mov_b32 v18, 0
    v_mov_b32 v19, 0
    s_cmp_lg_u32 s13, 0
    s_cbranch_scc1 L_sf4
    v_mov_b32 v14, 1
    s_mov_b32 exec_lo, 0x1
    s_mov_b32 exec_hi, 0x0
    buffer_store_dword v14, v201, s[52:55], s61 offen sc1
    s_mov_b64 exec, -1
L_sf4:
    s_mov_b32 exec_hi, 0
    ds_write_b128 v12, v[16:19] offset:8448
    ds_write_b128 v12, v[16:19] offset:13088
    s_mov_b64 exec, -1
    s_cmp_lg_u32 s13, 0
    s_cbranch_scc1 L_B_w1
    s_mov_b32 s43, 0
    s_mov_b32 exec_lo, 0x3ff
    s_mov_b32 exec_hi, 0x0
    s_branch L_ff6
L_fp5:
    s_sleep 4
L_ff6:
    buffer_load_dword v200, v202, s[52:55], s60 offen sc1
    s_add_u32 s43, s43, 1
    s_waitcnt vmcnt(0)
    v_cmp_eq_u32 vcc, 0, v200
    s_lshr_b32 s42, s43, 16
    s_cmp_lg_u32 s42, 0
    s_cbranch_scc1 L_fd7
    s_nop 1
    s_cmp_eq_u64 vcc, 0
    s_cbranch_scc0 L_fp5
L_fd7:
    s_mov_b64 exec, -1
L_B_w1:
    s_barrier
    s_cmp_eq_u32 s81, 0
    s_cbranch_scc0 L_conv_b
    s_add_u32 m0, s9, 0
    s_nop 0
    buffer_load_dwordx4 v3, s[52:55], s10 offen offset:0 lds
    buffer_load_dwordx4 v3, s[52:55], s10 offen offset:1024 lds
    buffer_load_dwordx4 v3, s[52:55], s10 offen offset:2048 lds
    s_add_u32 m0, s9, 8960
    s_nop 0
    buffer_load_dwordx4 v3, s[52:55], s12 offen offset:0 lds
    buffer_load_dwordx4 v3, s[52:55], s12 offen offset:1024 lds
    buffer_load_dwordx4 v3, s[52:55], s12 offen offset:2048 lds
    buffer_load_dwordx4 v3, s[52:55], s12 offen offset:3072 lds
    s_add_u32 m0, s9, 13600
    s_nop 0
    buffer_load_dwordx4 v3, s[52:55], s14 offen offset:0 lds
    buffer_load_dwordx4 v3, s[52:55], s14 offen offset:1024 lds
    buffer_load_dwordx4 v3, s[52:55], s14 offen offset:2048 lds
    buffer_load_dwordx4 v3, s[52:55], s14 offen offset:3072 lds
    v_mov_b32 v20, 0
    v_mov_b32 v21, 0
    v_mov_b32 v22, 0
    v_mov_b32 v23, 0
    v_mov_b32 v24, 0
    v_mov_b32 v25, 0
    v_mov_b32 v26, 0
    v_mov_b32 v27, 0
    v_mov_b32 v28, 0
    v_mov_b32 v29, 0
    v_mov_b32 v30, 0
    v_mov_b32 v31, 0
    v_mov_b32 v32, 0
    v_mov_b32 v33, 0
    v_mov_b32 v34, 0
    v_mov_b32 v35, 0
    s_waitcnt vmcnt(8)
    ds_read2_b32 v[40:41], v8 offset0:64 offset1:65
    ds_read2_b32 v[44:45], v8 offset0:0 offset1:1
    ds_read_b64 v[48:49], v9
    ds_read_b32 v50, v9 offset:8
    s_mov_b32 exec_hi, 0
    ds_read_b128 v[52:55], v10 offset:4
    ds_read_b32 v67, v10 offset:20
    ds_read_b32 v56, v10
    s_mov_b32 exec_lo, 0
    s_mov_b32 exec_hi, -1
    ds_read_b128 v[60:63], v11 offset:4
    ds_read_b128 v[64:67], v11 offset:20
    ds_read_b32 v59, v11
    s_mov_b32 exec_lo, -1
    s_mov_b32 exec_hi, 0
    s_waitcnt lgkmcnt(0)
    v_cndmask_b32 v59, v52, v56, s[4:5]
    v_mov_b32 v60, v52
    v_mov_b32 v61, v52
    v_mov_b32 v62, v53
    v_mov_b32 v63, v54
    v_mov_b32 v64, v54
    v_mov_b32 v65, v54
    v_mov_b32 v66, v55
    s_mov_b32 exec_lo, 15
    ds_write_b128 v12, v[16:19] offset:4096
    ds_write_b128 v12, v[16:19] offset:8320
    s_mov_b64 exec, -1
    v_cvt_pk_bf16_f32 v72, v67, v66
    v_cvt_pk_bf16_f32 v73, v65, v64
    v_cvt_pk_bf16_f32 v74, v63, v62
    v_cvt_pk_bf16_f32 v75, v61, v60
    v_cvt_pk_bf16_f32 v76, v66, v65
    v_cvt_pk_bf16_f32 v77, v64, v63
    v_cvt_pk_bf16_f32 v78, v62, v61
    v_cvt_pk_bf16_f32 v79, v60, v59
    ds_write_b128 v12, v[72:75] offset:7296
    ds_write_b128 v12, v[76:79] offset:3072
    v_cvt_pk_bf16_f32 v80, v50, v50
    v_cvt_pk_bf16_f32 v81, v49, v49
    v_cvt_pk_bf16_f32 v82, v49, v48
    v_cvt_pk_bf16_f32 v83, v48, v48
    v_cvt_pk_bf16_f32 v84, v50, v49
    v_mov_b32 v85, v81
    v_mov_b32 v86, v83
    v_mov_b32 v87, v83
    ds_write_b128 v12, v[80:83] offset:6272
    ds_write_b128 v12, v[84:87] offset:2048
    v_cndmask_b32 v46, v45, v44, s[6:7]
    v_cvt_pk_bf16_f32 v96, v45, v45
    v_cvt_pk_bf16_f32 v98, v44, v44
    v_cvt_pk_bf16_f32 v97, v45, v46
    v_cvt_pk_bf16_f32 v101, v46, v44
    v_mov_b32 v99, v98
    v_mov_b32 v100, v96
    v_mov_b32 v102, v98
    v_mov_b32 v103, v98
    ds_write_b128 v12, v[96:99] offset:5248
    ds_write_b128 v12, v[100:103] offset:1024
    v_cndmask_b32 v42, v41, v40, s[6:7]
    v_cvt_pk_bf16_f32 v88, v41, v41
    v_cvt_pk_bf16_f32 v90, v40, v40
    v_cvt_pk_bf16_f32 v89, v41, v42
    v_cvt_pk_bf16_f32 v93, v42, v40
    v_mov_b32 v91, v90
    v_mov_b32 v92, v88
    v_mov_b32 v94, v90
    v_mov_b32 v95, v90
    ds_write_b128 v12, v[88:91] offset:4224
    ds_write_b128 v12, v[92:95] offset:0
    s_waitcnt vmcnt(0)
    s_mov_b64 exec, 1
    ds_write_b32 v12, v16 offset:13600
    s_mov_b64 exec, -1
    s_waitcnt lgkmcnt(0)
    ds_read_b64 v[40:41], v4 offset:4032
    ds_read_b64 v[42:43], v4 offset:4040
    ds_read_b128 v[100:103], v5 offset:4032
    ds_read_b64 v[44:45], v4 offset:3520
    ds_read_b64 v[46:47], v4 offset:3528
    ds_read_b128 v[96:99], v5 offset:3520
    ds_read_b64 v[48:49], v4 offset:3008
    ds_read_b64 v[50:51], v4 offset:3016
    ds_read_b128 v[92:95], v5 offset:3008
    ds_read_b64 v[52:53], v4 offset:2496
    ds_read_b64 v[54:55], v4 offset:2504
    ds_read_b128 v[88:91], v5 offset:2496
    ds_read_b64 v[56:57], v4 offset:1984
    ds_read_b64 v[58:59], v4 offset:1992
    ds_read_b128 v[84:87], v5 offset:1984
    ds_read_b64 v[60:61], v4 offset:1472
    ds_read_b64 v[62:63], v4 offset:1480
    ds_read_b128 v[80:83], v5 offset:1472
    ds_read_b64 v[64:65], v4 offset:960
    ds_read_b64 v[66:67], v4 offset:968
    ds_read_b128 v[76:79], v5 offset:960
    ds_read_b64 v[68:69], v4 offset:448
    ds_read_b64 v[70:71], v4 offset:456
    ds_read_b128 v[72:75], v5 offset:448
    s_waitcnt lgkmcnt(0)
    v_mfma_f32_16x16x32_bf16 v[20:23], v[40:43], v[100:103], v[20:23]
    ds_read_b64 v[104:105], v4 offset:3968
    ds_read_b64 v[106:107], v4 offset:3976
    v_mfma_f32_16x16x32_bf16 v[20:23], v[44:47], v[96:99], v[20:23]
    ds_read_b128 v[164:167], v5 offset:3968
    ds_read_b64 v[108:109], v4 offset:3456
    v_mfma_f32_16x16x32_bf16 v[20:23], v[48:51], v[92:95], v[20:23]
    ds_read_b64 v[110:111], v4 offset:3464
    ds_read_b128 v[160:163], v5 offset:3456
    v_mfma_f32_16x16x32_bf16 v[20:23], v[52:55], v[88:91], v[20:23]
    ds_read_b64 v[112:113], v4 offset:2944
    ds_read_b64 v[114:115], v4 offset:2952
    v_mfma_f32_16x16x32_bf16 v[20:23], v[56:59], v[84:87], v[20:23]
    ds_read_b128 v[156:159], v5 offset:2944
    ds_read_b64 v[116:117], v4 offset:2432
    v_mfma_f32_16x16x32_bf16 v[20:23], v[60:63], v[80:83], v[20:23]
    ds_read_b64 v[118:119], v4 offset:2440
    ds_read_b128 v[152:155], v5 offset:2432
    v_mfma_f32_16x16x32_bf16 v[20:23], v[64:67], v[76:79], v[20:23]
    ds_read_b64 v[120:121], v4 offset:1920
    ds_read_b64 v[122:123], v4 offset:1928
    v_mfma_f32_16x16x32_bf16 v[20:23], v[68:71], v[72:75], v[20:23]
    ds_read_b128 v[148:151], v5 offset:1920
    ds_read_b64 v[124:125], v4 offset:1408
    v_mfma_f32_16x16x32_bf16 v[24:27], v[40:43], v[96:99], v[24:27]
    ds_read_b64 v[126:127], v4 offset:1416
    ds_read_b128 v[144:147], v5 offset:1408
    v_mfma_f32_16x16x32_bf16 v[24:27], v[44:47], v[92:95], v[24:27]
    ds_read_b64 v[128:129], v4 offset:896
    ds_read_b64 v[130:131], v4 offset:904
    v_mfma_f32_16x16x32_bf16 v[24:27], v[48:51], v[88:91], v[24:27]
    ds_read_b128 v[140:143], v5 offset:896
    ds_read_b64 v[132:133], v4 offset:384
    v_mfma_f32_16x16x32_bf16 v[24:27], v[52:55], v[84:87], v[24:27]
    ds_read_b64 v[134:135], v4 offset:392
    ds_read_b128 v[136:139], v5 offset:384
    v_mfma_f32_16x16x32_bf16 v[24:27], v[56:59], v[80:83], v[24:27]
    v_mfma_f32_16x16x32_bf16 v[24:27], v[60:63], v[76:79], v[24:27]
    v_mfma_f32_16x16x32_bf16 v[24:27], v[64:67], v[72:75], v[24:27]
    v_mfma_f32_16x16x32_bf16 v[28:31], v[40:43], v[76:79], v[28:31]
    v_mfma_f32_16x16x32_bf16 v[28:31], v[44:47], v[72:75], v[28:31]
    v_mfma_f32_16x16x32_bf16 v[32:35], v[40:43], v[72:75], v[32:35]
    s_waitcnt lgkmcnt(0)
    v_mfma_f32_16x16x32_bf16 v[20:23], v[104:107], v[164:167], v[20:23]
    ds_read_b64 v[40:41], v4 offset:3904
    ds_read_b64 v[42:43], v4 offset:3912
    v_mfma_f32_16x16x32_bf16 v[20:23], v[108:111], v[160:163], v[20:23]
    ds_read_b128 v[100:103], v5 offset:3904
    ds_read_b64 v[44:45], v4 offset:3392
    v_mfma_f32_16x16x32_bf16 v[20:23], v[112:115], v[156:159], v[20:23]
    ds_read_b64 v[46:47], v4 offset:3400
    ds_read_b128 v[96:99], v5 offset:3392
    v_mfma_f32_16x16x32_bf16 v[20:23], v[116:119], v[152:155], v[20:23]
    ds_read_b64 v[48:49], v4 offset:2880
    ds_read_b64 v[50:51], v4 offset:2888
    v_mfma_f32_16x16x32_bf16 v[20:23], v[120:123], v[148:151], v[20:23]
    ds_read_b128 v[92:95], v5 offset:2880
    ds_read_b64 v[52:53], v4 offset:2368
    v_mfma_f32_16x16x32_bf16 v[20:23], v[124:127], v[144:147], v[20:23]
    ds_read_b64 v[54:55], v4 offset:2376
    ds_read_b128 v[88:91], v5 offset:2368
    v_mfma_f32_16x16x32_bf16 v[20:23], v[128:131], v[140:143], v[20:23]
    ds_read_b64 v[56:57], v4 offset:1856
    ds_read_b64 v[58:59], v4 offset:1864
    v_mfma_f32_16x16x32_bf16 v[20:23], v[132:135], v[136:139], v[20:23]
    ds_read_b128 v[84:87], v5 offset:1856
    ds_read_b64 v[60:61], v4 offset:1344
    v_mfma_f32_16x16x32_bf16 v[24:27], v[104:107], v[160:163], v[24:27]
    ds_read_b64 v[62:63], v4 offset:1352
    ds_read_b128 v[80:83], v5 offset:1344
    v_mfma_f32_16x16x32_bf16 v[24:27], v[108:111], v[156:159], v[24:27]
    ds_read_b64 v[64:65], v4 offset:832
    ds_read_b64 v[66:67], v4 offset:840
    v_mfma_f32_16x16x32_bf16 v[24:27], v[112:115], v[152:155], v[24:27]
    ds_read_b128 v[76:79], v5 offset:832
    ds_read_b64 v[68:69], v4 offset:320
    v_mfma_f32_16x16x32_bf16 v[24:27], v[116:119], v[148:151], v[24:27]
    ds_read_b64 v[70:71], v4 offset:328
    ds_read_b128 v[72:75], v5 offset:320
    v_mfma_f32_16x16x32_bf16 v[24:27], v[120:123], v[144:147], v[24:27]
    v_mfma_f32_16x16x32_bf16 v[24:27], v[124:127], v[140:143], v[24:27]
    v_mfma_f32_16x16x32_bf16 v[24:27], v[128:131], v[136:139], v[24:27]
    v_mfma_f32_16x16x32_bf16 v[28:31], v[104:107], v[140:143], v[28:31]
    v_mfma_f32_16x16x32_bf16 v[28:31], v[108:111], v[136:139], v[28:31]
    v_mfma_f32_16x16x32_bf16 v[32:35], v[104:107], v[136:139], v[32:35]
    s_waitcnt lgkmcnt(0)
    v_mfma_f32_16x16x32_bf16 v[20:23], v[40:43], v[100:103], v[20:23]
    ds_read_b64 v[104:105], v4 offset:3840
    ds_read_b64 v[106:107], v4 offset:3848
    v_mfma_f32_16x16x32_bf16 v[20:23], v[44:47], v[96:99], v[20:23]
    ds_read_b128 v[164:167], v5 offset:3840
    ds_read_b64 v[108:109], v4 offset:3328
    v_mfma_f32_16x16x32_bf16 v[20:23], v[48:51], v[92:95], v[20:23]
    ds_read_b64 v[110:111], v4 offset:3336
    ds_read_b128 v[160:163], v5 offset:3328
    v_mfma_f32_16x16x32_bf16 v[20:23], v[52:55], v[88:91], v[20:23]
    ds_read_b64 v[112:113], v4 offset:2816
    ds_read_b64 v[114:115], v4 offset:2824
    v_mfma_f32_16x16x32_bf16 v[20:23], v[56:59], v[84:87], v[20:23]
    ds_read_b128 v[156:159], v5 offset:2816
    ds_read_b64 v[116:117], v4 offset:2304
    v_mfma_f32_16x16x32_bf16 v[20:23], v[60:63], v[80:83], v[20:23]
    ds_read_b64 v[118:119], v4 offset:2312
    ds_read_b128 v[152:155], v5 offset:2304
    v_mfma_f32_16x16x32_bf16 v[20:23], v[64:67], v[76:79], v[20:23]
    ds_read_b64 v[120:121], v4 offset:1792
    ds_read_b64 v[122:123], v4 offset:1800
    v_mfma_f32_16x16x32_bf16 v[20:23], v[68:71], v[72:75], v[20:23]
    ds_read_b128 v[148:151], v5 offset:1792
    ds_read_b64 v[124:125], v4 offset:1280
    v_mfma_f32_16x16x32_bf16 v[24:27], v[40:43], v[96:99], v[24:27]
    ds_read_b64 v[126:127], v4 offset:1288
    ds_read_b128 v[144:147], v5 offset:1280
    v_mfma_f32_16x16x32_bf16 v[24:27], v[44:47], v[92:95], v[24:27]
    ds_read_b64 v[128:129], v4 offset:768
    ds_read_b64 v[130:131], v4 offset:776
    v_mfma_f32_16x16x32_bf16 v[24:27], v[48:51], v[88:91], v[24:27]
    ds_read_b128 v[140:143], v5 offset:768
    ds_read_b64 v[132:133], v4 offset:256
    v_mfma_f32_16x16x32_bf16 v[24:27], v[52:55], v[84:87], v[24:27]
    ds_read_b64 v[134:135], v4 offset:264
    ds_read_b128 v[136:139], v5 offset:256
    v_mfma_f32_16x16x32_bf16 v[24:27], v[56:59], v[80:83], v[24:27]
    v_mfma_f32_16x16x32_bf16 v[24:27], v[60:63], v[76:79], v[24:27]
    v_mfma_f32_16x16x32_bf16 v[24:27], v[64:67], v[72:75], v[24:27]
    v_mfma_f32_16x16x32_bf16 v[28:31], v[40:43], v[76:79], v[28:31]
    v_mfma_f32_16x16x32_bf16 v[28:31], v[44:47], v[72:75], v[28:31]
    v_mfma_f32_16x16x32_bf16 v[32:35], v[40:43], v[72:75], v[32:35]
    s_waitcnt lgkmcnt(0)
    v_mfma_f32_16x16x32_bf16 v[20:23], v[104:107], v[164:167], v[20:23]
    ds_read_b64 v[40:41], v4 offset:3776
    ds_read_b64 v[42:43], v4 offset:3784
    v_mfma_f32_16x16x32_bf16 v[20:23], v[108:111], v[160:163], v[20:23]
    ds_read_b128 v[100:103], v5 offset:3776
    ds_read_b64 v[44:45], v4 offset:3264
    v_mfma_f32_16x16x32_bf16 v[20:23], v[112:115], v[156:159], v[20:23]
    ds_read_b64 v[46:47], v4 offset:3272
    ds_read_b128 v[96:99], v5 offset:3264
    v_mfma_f32_16x16x32_bf16 v[20:23], v[116:119], v[152:155], v[20:23]
    ds_read_b64 v[48:49], v4 offset:2752
    ds_read_b64 v[50:51], v4 offset:2760
    v_mfma_f32_16x16x32_bf16 v[20:23], v[120:123], v[148:151], v[20:23]
    ds_read_b128 v[92:95], v5 offset:2752
    ds_read_b64 v[52:53], v4 offset:2240
    v_mfma_f32_16x16x32_bf16 v[20:23], v[124:127], v[144:147], v[20:23]
    ds_read_b64 v[54:55], v4 offset:2248
    ds_read_b128 v[88:91], v5 offset:2240
    v_mfma_f32_16x16x32_bf16 v[20:23], v[128:131], v[140:143], v[20:23]
    ds_read_b64 v[56:57], v4 offset:1728
    ds_read_b64 v[58:59], v4 offset:1736
    v_mfma_f32_16x16x32_bf16 v[20:23], v[132:135], v[136:139], v[20:23]
    ds_read_b128 v[84:87], v5 offset:1728
    ds_read_b64 v[60:61], v4 offset:1216
    v_mfma_f32_16x16x32_bf16 v[24:27], v[104:107], v[160:163], v[24:27]
    ds_read_b64 v[62:63], v4 offset:1224
    ds_read_b128 v[80:83], v5 offset:1216
    v_mfma_f32_16x16x32_bf16 v[24:27], v[108:111], v[156:159], v[24:27]
    ds_read_b64 v[64:65], v4 offset:704
    ds_read_b64 v[66:67], v4 offset:712
    v_mfma_f32_16x16x32_bf16 v[24:27], v[112:115], v[152:155], v[24:27]
    ds_read_b128 v[76:79], v5 offset:704
    ds_read_b64 v[68:69], v4 offset:192
    v_mfma_f32_16x16x32_bf16 v[24:27], v[116:119], v[148:151], v[24:27]
    ds_read_b64 v[70:71], v4 offset:200
    ds_read_b128 v[72:75], v5 offset:192
    v_mfma_f32_16x16x32_bf16 v[24:27], v[120:123], v[144:147], v[24:27]
    v_mfma_f32_16x16x32_bf16 v[24:27], v[124:127], v[140:143], v[24:27]
    v_mfma_f32_16x16x32_bf16 v[24:27], v[128:131], v[136:139], v[24:27]
    v_mfma_f32_16x16x32_bf16 v[28:31], v[104:107], v[140:143], v[28:31]
    v_mfma_f32_16x16x32_bf16 v[28:31], v[108:111], v[136:139], v[28:31]
    v_mfma_f32_16x16x32_bf16 v[32:35], v[104:107], v[136:139], v[32:35]
    s_waitcnt lgkmcnt(0)
    v_mfma_f32_16x16x32_bf16 v[20:23], v[40:43], v[100:103], v[20:23]
    ds_read_b64 v[104:105], v4 offset:3712
    ds_read_b64 v[106:107], v4 offset:3720
    v_mfma_f32_16x16x32_bf16 v[20:23], v[44:47], v[96:99], v[20:23]
    ds_read_b128 v[164:167], v5 offset:3712
    ds_read_b64 v[108:109], v4 offset:3200
    v_mfma_f32_16x16x32_bf16 v[20:23], v[48:51], v[92:95], v[20:23]
    ds_read_b64 v[110:111], v4 offset:3208
    ds_read_b128 v[160:163], v5 offset:3200
    v_mfma_f32_16x16x32_bf16 v[20:23], v[52:55], v[88:91], v[20:23]
    ds_read_b64 v[112:113], v4 offset:2688
    ds_read_b64 v[114:115], v4 offset:2696
    v_mfma_f32_16x16x32_bf16 v[20:23], v[56:59], v[84:87], v[20:23]
    ds_read_b128 v[156:159], v5 offset:2688
    ds_read_b64 v[116:117], v4 offset:2176
    v_mfma_f32_16x16x32_bf16 v[20:23], v[60:63], v[80:83], v[20:23]
    ds_read_b64 v[118:119], v4 offset:2184
    ds_read_b128 v[152:155], v5 offset:2176
    v_mfma_f32_16x16x32_bf16 v[20:23], v[64:67], v[76:79], v[20:23]
    ds_read_b64 v[120:121], v4 offset:1664
    ds_read_b64 v[122:123], v4 offset:1672
    v_mfma_f32_16x16x32_bf16 v[20:23], v[68:71], v[72:75], v[20:23]
    ds_read_b128 v[148:151], v5 offset:1664
    ds_read_b64 v[124:125], v4 offset:1152
    v_mfma_f32_16x16x32_bf16 v[24:27], v[40:43], v[96:99], v[24:27]
    ds_read_b64 v[126:127], v4 offset:1160
    ds_read_b128 v[144:147], v5 offset:1152
    v_mfma_f32_16x16x32_bf16 v[24:27], v[44:47], v[92:95], v[24:27]
    ds_read_b64 v[128:129], v4 offset:640
    ds_read_b64 v[130:131], v4 offset:648
    v_mfma_f32_16x16x32_bf16 v[24:27], v[48:51], v[88:91], v[24:27]
    ds_read_b128 v[140:143], v5 offset:640
    ds_read_b64 v[132:133], v4 offset:128
    v_mfma_f32_16x16x32_bf16 v[24:27], v[52:55], v[84:87], v[24:27]
    ds_read_b64 v[134:135], v4 offset:136
    ds_read_b128 v[136:139], v5 offset:128
    v_mfma_f32_16x16x32_bf16 v[24:27], v[56:59], v[80:83], v[24:27]
    v_mfma_f32_16x16x32_bf16 v[24:27], v[60:63], v[76:79], v[24:27]
    v_mfma_f32_16x16x32_bf16 v[24:27], v[64:67], v[72:75], v[24:27]
    v_mfma_f32_16x16x32_bf16 v[28:31], v[40:43], v[76:79], v[28:31]
    v_mfma_f32_16x16x32_bf16 v[28:31], v[44:47], v[72:75], v[28:31]
    v_mfma_f32_16x16x32_bf16 v[32:35], v[40:43], v[72:75], v[32:35]
    s_waitcnt lgkmcnt(0)
    v_mfma_f32_16x16x32_bf16 v[20:23], v[104:107], v[164:167], v[20:23]
    ds_read_b64 v[40:41], v4 offset:3648
    ds_read_b64 v[42:43], v4 offset:3656
    v_mfma_f32_16x16x32_bf16 v[20:23], v[108:111], v[160:163], v[20:23]
    ds_read_b128 v[100:103], v5 offset:3648
    ds_read_b64 v[44:45], v4 offset:3136
    v_mfma_f32_16x16x32_bf16 v[20:23], v[112:115], v[156:159], v[20:23]
    ds_read_b64 v[46:47], v4 offset:3144
    ds_read_b128 v[96:99], v5 offset:3136
    v_mfma_f32_16x16x32_bf16 v[20:23], v[116:119], v[152:155], v[20:23]
    ds_read_b64 v[48:49], v4 offset:2624
    ds_read_b64 v[50:51], v4 offset:2632
    v_mfma_f32_16x16x32_bf16 v[20:23], v[120:123], v[148:151], v[20:23]
    ds_read_b128 v[92:95], v5 offset:2624
    ds_read_b64 v[52:53], v4 offset:2112
    v_mfma_f32_16x16x32_bf16 v[20:23], v[124:127], v[144:147], v[20:23]
    ds_read_b64 v[54:55], v4 offset:2120
    ds_read_b128 v[88:91], v5 offset:2112
    v_mfma_f32_16x16x32_bf16 v[20:23], v[128:131], v[140:143], v[20:23]
    ds_read_b64 v[56:57], v4 offset:1600
    ds_read_b64 v[58:59], v4 offset:1608
    v_mfma_f32_16x16x32_bf16 v[20:23], v[132:135], v[136:139], v[20:23]
    ds_read_b128 v[84:87], v5 offset:1600
    ds_read_b64 v[60:61], v4 offset:1088
    v_mfma_f32_16x16x32_bf16 v[24:27], v[104:107], v[160:163], v[24:27]
    ds_read_b64 v[62:63], v4 offset:1096
    ds_read_b128 v[80:83], v5 offset:1088
    v_mfma_f32_16x16x32_bf16 v[24:27], v[108:111], v[156:159], v[24:27]
    ds_read_b64 v[64:65], v4 offset:576
    ds_read_b64 v[66:67], v4 offset:584
    v_mfma_f32_16x16x32_bf16 v[24:27], v[112:115], v[152:155], v[24:27]
    ds_read_b128 v[76:79], v5 offset:576
    ds_read_b64 v[68:69], v4 offset:64
    v_mfma_f32_16x16x32_bf16 v[24:27], v[116:119], v[148:151], v[24:27]
    ds_read_b64 v[70:71], v4 offset:72
    ds_read_b128 v[72:75], v5 offset:64
    v_mfma_f32_16x16x32_bf16 v[24:27], v[120:123], v[144:147], v[24:27]
    v_mfma_f32_16x16x32_bf16 v[24:27], v[124:127], v[140:143], v[24:27]
    v_mfma_f32_16x16x32_bf16 v[24:27], v[128:131], v[136:139], v[24:27]
    v_mfma_f32_16x16x32_bf16 v[28:31], v[104:107], v[140:143], v[28:31]
    v_mfma_f32_16x16x32_bf16 v[28:31], v[108:111], v[136:139], v[28:31]
    v_mfma_f32_16x16x32_bf16 v[32:35], v[104:107], v[136:139], v[32:35]
    s_waitcnt lgkmcnt(0)
    v_mfma_f32_16x16x32_bf16 v[20:23], v[40:43], v[100:103], v[20:23]
    ds_read_b64 v[104:105], v4 offset:3584
    ds_read_b64 v[106:107], v4 offset:3592
    v_mfma_f32_16x16x32_bf16 v[20:23], v[44:47], v[96:99], v[20:23]
    ds_read_b128 v[164:167], v5 offset:3584
    ds_read_b64 v[108:109], v4 offset:3072
    v_mfma_f32_16x16x32_bf16 v[20:23], v[48:51], v[92:95], v[20:23]
    ds_read_b64 v[110:111], v4 offset:3080
    ds_read_b128 v[160:163], v5 offset:3072
    v_mfma_f32_16x16x32_bf16 v[20:23], v[52:55], v[88:91], v[20:23]
    ds_read_b64 v[112:113], v4 offset:2560
    ds_read_b64 v[114:115], v4 offset:2568
    v_mfma_f32_16x16x32_bf16 v[20:23], v[56:59], v[84:87], v[20:23]
    ds_read_b128 v[156:159], v5 offset:2560
    ds_read_b64 v[116:117], v4 offset:2048
    v_mfma_f32_16x16x32_bf16 v[20:23], v[60:63], v[80:83], v[20:23]
    ds_read_b64 v[118:119], v4 offset:2056
    ds_read_b128 v[152:155], v5 offset:2048
    v_mfma_f32_16x16x32_bf16 v[20:23], v[64:67], v[76:79], v[20:23]
    ds_read_b64 v[120:121], v4 offset:1536
    ds_read_b64 v[122:123], v4 offset:1544
    v_mfma_f32_16x16x32_bf16 v[20:23], v[68:71], v[72:75], v[20:23]
    ds_read_b128 v[148:151], v5 offset:1536
    ds_read_b64 v[124:125], v4 offset:1024
    v_mfma_f32_16x16x32_bf16 v[24:27], v[40:43], v[96:99], v[24:27]
    ds_read_b64 v[126:127], v4 offset:1032
    ds_read_b128 v[144:147], v5 offset:1024
    v_mfma_f32_16x16x32_bf16 v[24:27], v[44:47], v[92:95], v[24:27]
    ds_read_b64 v[128:129], v4 offset:512
    ds_read_b64 v[130:131], v4 offset:520
    v_mfma_f32_16x16x32_bf16 v[24:27], v[48:51], v[88:91], v[24:27]
    ds_read_b128 v[140:143], v5 offset:512
    ds_read_b64 v[132:133], v4 offset:0
    v_mfma_f32_16x16x32_bf16 v[24:27], v[52:55], v[84:87], v[24:27]
    ds_read_b64 v[134:135], v4 offset:8
    ds_read_b128 v[136:139], v5 offset:0
    v_mfma_f32_16x16x32_bf16 v[24:27], v[56:59], v[80:83], v[24:27]
    v_mfma_f32_16x16x32_bf16 v[24:27], v[60:63], v[76:79], v[24:27]
    v_mfma_f32_16x16x32_bf16 v[24:27], v[64:67], v[72:75], v[24:27]
    v_mfma_f32_16x16x32_bf16 v[28:31], v[40:43], v[76:79], v[28:31]
    v_mfma_f32_16x16x32_bf16 v[28:31], v[44:47], v[72:75], v[28:31]
    v_mfma_f32_16x16x32_bf16 v[32:35], v[40:43], v[72:75], v[32:35]
    s_waitcnt lgkmcnt(0)
    v_mfma_f32_16x16x32_bf16 v[20:23], v[104:107], v[164:167], v[20:23]
    v_mfma_f32_16x16x32_bf16 v[20:23], v[108:111], v[160:163], v[20:23]
    v_mfma_f32_16x16x32_bf16 v[20:23], v[112:115], v[156:159], v[20:23]
    v_mfma_f32_16x16x32_bf16 v[20:23], v[116:119], v[152:155], v[20:23]
    v_mfma_f32_16x16x32_bf16 v[20:23], v[120:123], v[148:151], v[20:23]
    v_mfma_f32_16x16x32_bf16 v[20:23], v[124:127], v[144:147], v[20:23]
    v_mfma_f32_16x16x32_bf16 v[20:23], v[128:131], v[140:143], v[20:23]
    v_mfma_f32_16x16x32_bf16 v[20:23], v[132:135], v[136:139], v[20:23]
    v_mfma_f32_16x16x32_bf16 v[24:27], v[104:107], v[160:163], v[24:27]
    v_mfma_f32_16x16x32_bf16 v[24:27], v[108:111], v[156:159], v[24:27]
    v_mfma_f32_16x16x32_bf16 v[24:27], v[112:115], v[152:155], v[24:27]
    v_mfma_f32_16x16x32_bf16 v[24:27], v[116:119], v[148:151], v[24:27]
    v_mfma_f32_16x16x32_bf16 v[24:27], v[120:123], v[144:147], v[24:27]
    v_mfma_f32_16x16x32_bf16 v[24:27], v[124:127], v[140:143], v[24:27]
    v_mfma_f32_16x16x32_bf16 v[24:27], v[128:131], v[136:139], v[24:27]
    v_mfma_f32_16x16x32_bf16 v[28:31], v[104:107], v[140:143], v[28:31]
    v_mfma_f32_16x16x32_bf16 v[28:31], v[108:111], v[136:139], v[28:31]
    v_mfma_f32_16x16x32_bf16 v[32:35], v[104:107], v[136:139], v[32:35]
    v_cvt_pk_bf16_f32 v40, v20, v21
    v_cvt_pk_bf16_f32 v41, v22, v23
    s_nop 2
    v_cvt_pk_bf16_f32 v42, v24, v25
    v_cvt_pk_bf16_f32 v43, v26, v27
    v_cvt_pk_bf16_f32 v44, v28, v29
    v_cvt_pk_bf16_f32 v45, v30, v31
    v_cvt_pk_bf16_f32 v46, v32, v33
    v_cvt_pk_bf16_f32 v47, v34, v35
    ds_write2_b32 v6, v40, v41 offset0:0 offset1:2
    ds_write2_b32 v6, v42, v43 offset0:128 offset1:130
    ds_write2_b32 v7, v44, v45 offset0:0 offset1:2
    ds_write2_b32 v7, v46, v47 offset0:128 offset1:130
    s_movk_i32 s15, 7
    s_cmp_eq_u32 s13, 1
    s_cselect_b32 s15, 6, s15
    s_cmp_eq_u32 s13, 2
    s_cselect_b32 s15, 1, s15
    s_cmp_eq_u32 s13, 3
    s_cselect_b32 s15, 0, s15
    s_lshl_b32 s15, s15, 19
    s_lshl_b32 s7, s80, 1
    s_add_u32 s15, s15, s7
    s_add_u32 s15, s15, 1024
    v_lshlrev_b32 v8, 3, v0
    v_lshlrev_b32 v9, 13, v2
    v_add_u32 v10, 4096, v9
    s_mov_b32 s8, 0x05040100
    s_mov_b32 s9, 0x07060302
    s_waitcnt lgkmcnt(0)
    s_barrier
    ds_read_b64 v[48:49], v8 offset:0
    ds_read_b64 v[50:51], v8 offset:17696
    ds_read_b64 v[52:53], v8 offset:35392
    ds_read_b64 v[54:55], v8 offset:53088
    s_waitcnt lgkmcnt(0)
    v_perm_b32 v56, v50, v48, s8
    v_perm_b32 v57, v54, v52, s8
    buffer_store_dwordx2 v[56:57], v9, s[44:47], s15 offen offset:0
    v_perm_b32 v58, v50, v48, s9
    v_perm_b32 v59, v54, v52, s9
    buffer_store_dwordx2 v[58:59], v9, s[44:47], s15 offen offset:2048
    v_perm_b32 v60, v51, v49, s8
    v_perm_b32 v61, v55, v53, s8
    buffer_store_dwordx2 v[60:61], v10, s[44:47], s15 offen offset:0
    v_perm_b32 v62, v51, v49, s9
    v_perm_b32 v63, v55, v53, s9
    buffer_store_dwordx2 v[62:63], v10, s[44:47], s15 offen offset:2048
    s_endpgm
L_conv_b:
    s_add_u32 m0, s9, 0
    s_nop 0
    buffer_load_dwordx4 v3, s[52:55], s10 offen offset:0 lds
    buffer_load_dwordx4 v3, s[52:55], s10 offen offset:1024 lds
    buffer_load_dwordx4 v3, s[52:55], s10 offen offset:2048 lds
    s_add_u32 m0, s9, 8960
    s_nop 0
    buffer_load_dwordx4 v3, s[52:55], s12 offen offset:0 lds
    buffer_load_dwordx4 v3, s[52:55], s12 offen offset:1024 lds
    buffer_load_dwordx4 v3, s[52:55], s12 offen offset:2048 lds
    s_add_u32 m0, s9, 13600
    s_nop 0
    buffer_load_dwordx4 v3, s[52:55], s14 offen offset:0 lds
    buffer_load_dwordx4 v3, s[52:55], s14 offen offset:1024 lds
    buffer_load_dwordx4 v3, s[52:55], s14 offen offset:2048 lds
    v_mov_b32 v20, 0
    v_mov_b32 v21, 0
    v_mov_b32 v22, 0
    v_mov_b32 v23, 0
    v_mov_b32 v24, 0
    v_mov_b32 v25, 0
    v_mov_b32 v26, 0
    v_mov_b32 v27, 0
    v_mov_b32 v28, 0
    v_mov_b32 v29, 0
    v_mov_b32 v30, 0
    v_mov_b32 v31, 0
    v_mov_b32 v32, 0
    v_mov_b32 v33, 0
    v_mov_b32 v34, 0
    v_mov_b32 v35, 0
    s_waitcnt vmcnt(6)
    ds_read2_b32 v[44:45], v8 offset0:0 offset1:1
    ds_read_b64 v[48:49], v9
    ds_read_b32 v50, v9 offset:8
    s_mov_b32 exec_hi, 0
    ds_read_b128 v[52:55], v10 offset:4
    ds_read_b32 v67, v10 offset:20
    ds_read_b32 v56, v10
    s_mov_b32 exec_lo, 0
    s_mov_b32 exec_hi, -1
    ds_read_b128 v[60:63], v11 offset:4
    ds_read_b128 v[64:67], v11 offset:20
    ds_read_b32 v59, v11
    s_mov_b32 exec_lo, -1
    s_mov_b32 exec_hi, 0
    s_waitcnt lgkmcnt(0)
    v_cndmask_b32 v59, v52, v56, s[4:5]
    v_mov_b32 v60, v52
    v_mov_b32 v61, v52
    v_mov_b32 v62, v53
    v_mov_b32 v63, v54
    v_mov_b32 v64, v54
    v_mov_b32 v65, v54
    v_mov_b32 v66, v55
    s_mov_b32 exec_lo, 15
    ds_write_b128 v12, v[16:19] offset:4096
    ds_write_b128 v12, v[16:19] offset:8320
    s_mov_b64 exec, -1
    v_cvt_pk_bf16_f32 v72, v67, v66
    v_cvt_pk_bf16_f32 v73, v65, v64
    v_cvt_pk_bf16_f32 v74, v63, v62
    v_cvt_pk_bf16_f32 v75, v61, v60
    v_cvt_pk_bf16_f32 v76, v66, v65
    v_cvt_pk_bf16_f32 v77, v64, v63
    v_cvt_pk_bf16_f32 v78, v62, v61
    v_cvt_pk_bf16_f32 v79, v60, v59
    ds_write_b128 v12, v[72:75] offset:7296
    ds_write_b128 v12, v[76:79] offset:3072
    v_cvt_pk_bf16_f32 v80, v50, v50
    v_cvt_pk_bf16_f32 v81, v49, v49
    v_cvt_pk_bf16_f32 v82, v49, v48
    v_cvt_pk_bf16_f32 v83, v48, v48
    v_cvt_pk_bf16_f32 v84, v50, v49
    v_mov_b32 v85, v81
    v_mov_b32 v86, v83
    v_mov_b32 v87, v83
    ds_write_b128 v12, v[80:83] offset:6272
    ds_write_b128 v12, v[84:87] offset:2048
    v_cndmask_b32 v46, v45, v44, s[6:7]
    v_cvt_pk_bf16_f32 v96, v45, v45
    v_cvt_pk_bf16_f32 v98, v44, v44
    v_cvt_pk_bf16_f32 v97, v45, v46
    v_cvt_pk_bf16_f32 v101, v46, v44
    v_mov_b32 v99, v98
    v_mov_b32 v100, v96
    v_mov_b32 v102, v98
    v_mov_b32 v103, v98
    ds_write_b128 v12, v[96:99] offset:5248
    ds_write_b128 v12, v[100:103] offset:1024
    s_waitcnt vmcnt(0)
    s_mov_b64 exec, 1
    ds_write_b32 v12, v16 offset:13600
    s_mov_b64 exec, -1
    s_waitcnt lgkmcnt(0)
    ds_read_b64 v[40:41], v4 offset:4032
    ds_read_b64 v[42:43], v4 offset:4040
    ds_read_b128 v[92:95], v5 offset:3008
    ds_read_b64 v[44:45], v4 offset:3520
    ds_read_b64 v[46:47], v4 offset:3528
    ds_read_b128 v[88:91], v5 offset:2496
    ds_read_b64 v[48:49], v4 offset:3008
    ds_read_b64 v[50:51], v4 offset:3016
    ds_read_b128 v[84:87], v5 offset:1984
    ds_read_b64 v[52:53], v4 offset:2496
    ds_read_b64 v[54:55], v4 offset:2504
    ds_read_b128 v[80:83], v5 offset:1472
    ds_read_b64 v[56:57], v4 offset:1984
    ds_read_b64 v[58:59], v4 offset:1992
    ds_read_b128 v[76:79], v5 offset:960
    ds_read_b64 v[60:61], v4 offset:1472
    ds_read_b64 v[62:63], v4 offset:1480
    ds_read_b128 v[72:75], v5 offset:448
    s_waitcnt lgkmcnt(0)
    v_mfma_f32_16x16x32_bf16 v[20:23], v[40:43], v[92:95], v[20:23]
    ds_read_b64 v[104:105], v4 offset:3968
    ds_read_b64 v[106:107], v4 offset:3976
    v_mfma_f32_16x16x32_bf16 v[20:23], v[44:47], v[88:91], v[20:23]
    ds_read_b128 v[156:159], v5 offset:2944
    ds_read_b64 v[108:109], v4 offset:3456
    v_mfma_f32_16x16x32_bf16 v[20:23], v[48:51], v[84:87], v[20:23]
    ds_read_b64 v[110:111], v4 offset:3464
    ds_read_b128 v[152:155], v5 offset:2432
    v_mfma_f32_16x16x32_bf16 v[20:23], v[52:55], v[80:83], v[20:23]
    ds_read_b64 v[112:113], v4 offset:2944
    ds_read_b64 v[114:115], v4 offset:2952
    v_mfma_f32_16x16x32_bf16 v[20:23], v[56:59], v[76:79], v[20:23]
    ds_read_b128 v[148:151], v5 offset:1920
    ds_read_b64 v[116:117], v4 offset:2432
    v_mfma_f32_16x16x32_bf16 v[20:23], v[60:63], v[72:75], v[20:23]
    ds_read_b64 v[118:119], v4 offset:2440
    ds_read_b128 v[144:147], v5 offset:1408
    v_mfma_f32_16x16x32_bf16 v[24:27], v[40:43], v[88:91], v[24:27]
    ds_read_b64 v[120:121], v4 offset:1920
    ds_read_b64 v[122:123], v4 offset:1928
    v_mfma_f32_16x16x32_bf16 v[24:27], v[44:47], v[84:87], v[24:27]
    ds_read_b128 v[140:143], v5 offset:896
    ds_read_b64 v[124:125], v4 offset:1408
    v_mfma_f32_16x16x32_bf16 v[24:27], v[48:51], v[80:83], v[24:27]
    ds_read_b64 v[126:127], v4 offset:1416
    ds_read_b128 v[136:139], v5 offset:384
    v_mfma_f32_16x16x32_bf16 v[24:27], v[52:55], v[76:79], v[24:27]
    v_mfma_f32_16x16x32_bf16 v[24:27], v[56:59], v[72:75], v[24:27]
    v_mfma_f32_16x16x32_bf16 v[28:31], v[40:43], v[84:87], v[28:31]
    v_mfma_f32_16x16x32_bf16 v[28:31], v[44:47], v[80:83], v[28:31]
    v_mfma_f32_16x16x32_bf16 v[28:31], v[48:51], v[76:79], v[28:31]
    v_mfma_f32_16x16x32_bf16 v[28:31], v[52:55], v[72:75], v[28:31]
    v_mfma_f32_16x16x32_bf16 v[32:35], v[40:43], v[80:83], v[32:35]
    v_mfma_f32_16x16x32_bf16 v[32:35], v[44:47], v[76:79], v[32:35]
    v_mfma_f32_16x16x32_bf16 v[32:35], v[48:51], v[72:75], v[32:35]
    s_waitcnt lgkmcnt(0)
    v_mfma_f32_16x16x32_bf16 v[20:23], v[104:107], v[156:159], v[20:23]
    ds_read_b64 v[40:41], v4 offset:3904
    ds_read_b64 v[42:43], v4 offset:3912
    v_mfma_f32_16x16x32_bf16 v[20:23], v[108:111], v[152:155], v[20:23]
    ds_read_b128 v[92:95], v5 offset:2880
    ds_read_b64 v[44:45], v4 offset:3392
    v_mfma_f32_16x16x32_bf16 v[20:23], v[112:115], v[148:151], v[20:23]
    ds_read_b64 v[46:47], v4 offset:3400
    ds_read_b128 v[88:91], v5 offset:2368
    v_mfma_f32_16x16x32_bf16 v[20:23], v[116:119], v[144:147], v[20:23]
    ds_read_b64 v[48:49], v4 offset:2880
    ds_read_b64 v[50:51], v4 offset:2888
    v_mfma_f32_16x16x32_bf16 v[20:23], v[120:123], v[140:143], v[20:23]
    ds_read_b128 v[84:87], v5 offset:1856
    ds_read_b64 v[52:53], v4 offset:2368
    v_mfma_f32_16x16x32_bf16 v[20:23], v[124:127], v[136:139], v[20:23]
    ds_read_b64 v[54:55], v4 offset:2376
    ds_read_b128 v[80:83], v5 offset:1344
    v_mfma_f32_16x16x32_bf16 v[24:27], v[104:107], v[152:155], v[24:27]
    ds_read_b64 v[56:57], v4 offset:1856
    ds_read_b64 v[58:59], v4 offset:1864
    v_mfma_f32_16x16x32_bf16 v[24:27], v[108:111], v[148:151], v[24:27]
    ds_read_b128 v[76:79], v5 offset:832
    ds_read_b64 v[60:61], v4 offset:1344
    v_mfma_f32_16x16x32_bf16 v[24:27], v[112:115], v[144:147], v[24:27]
    ds_read_b64 v[62:63], v4 offset:1352
    ds_read_b128 v[72:75], v5 offset:320
    v_mfma_f32_16x16x32_bf16 v[24:27], v[116:119], v[140:143], v[24:27]
    v_mfma_f32_16x16x32_bf16 v[24:27], v[120:123], v[136:139], v[24:27]
    v_mfma_f32_16x16x32_bf16 v[28:31], v[104:107], v[148:151], v[28:31]
    v_mfma_f32_16x16x32_bf16 v[28:31], v[108:111], v[144:147], v[28:31]
    v_mfma_f32_16x16x32_bf16 v[28:31], v[112:115], v[140:143], v[28:31]
    v_mfma_f32_16x16x32_bf16 v[28:31], v[116:119], v[136:139], v[28:31]
    v_mfma_f32_16x16x32_bf16 v[32:35], v[104:107], v[144:147], v[32:35]
    v_mfma_f32_16x16x32_bf16 v[32:35], v[108:111], v[140:143], v[32:35]
    v_mfma_f32_16x16x32_bf16 v[32:35], v[112:115], v[136:139], v[32:35]
    s_waitcnt lgkmcnt(0)
    v_mfma_f32_16x16x32_bf16 v[20:23], v[40:43], v[92:95], v[20:23]
    ds_read_b64 v[104:105], v4 offset:3840
    ds_read_b64 v[106:107], v4 offset:3848
    v_mfma_f32_16x16x32_bf16 v[20:23], v[44:47], v[88:91], v[20:23]
    ds_read_b128 v[156:159], v5 offset:2816
    ds_read_b64 v[108:109], v4 offset:3328
    v_mfma_f32_16x16x32_bf16 v[20:23], v[48:51], v[84:87], v[20:23]
    ds_read_b64 v[110:111], v4 offset:3336
    ds_read_b128 v[152:155], v5 offset:2304
    v_mfma_f32_16x16x32_bf16 v[20:23], v[52:55], v[80:83], v[20:23]
    ds_read_b64 v[112:113], v4 offset:2816
    ds_read_b64 v[114:115], v4 offset:2824
    v_mfma_f32_16x16x32_bf16 v[20:23], v[56:59], v[76:79], v[20:23]
    ds_read_b128 v[148:151], v5 offset:1792
    ds_read_b64 v[116:117], v4 offset:2304
    v_mfma_f32_16x16x32_bf16 v[20:23], v[60:63], v[72:75], v[20:23]
    ds_read_b64 v[118:119], v4 offset:2312
    ds_read_b128 v[144:147], v5 offset:1280
    v_mfma_f32_16x16x32_bf16 v[24:27], v[40:43], v[88:91], v[24:27]
    ds_read_b64 v[120:121], v4 offset:1792
    ds_read_b64 v[122:123], v4 offset:1800
    v_mfma_f32_16x16x32_bf16 v[24:27], v[44:47], v[84:87], v[24:27]
    ds_read_b128 v[140:143], v5 offset:768
    ds_read_b64 v[124:125], v4 offset:1280
    v_mfma_f32_16x16x32_bf16 v[24:27], v[48:51], v[80:83], v[24:27]
    ds_read_b64 v[126:127], v4 offset:1288
    ds_read_b128 v[136:139], v5 offset:256
    v_mfma_f32_16x16x32_bf16 v[24:27], v[52:55], v[76:79], v[24:27]
    v_mfma_f32_16x16x32_bf16 v[24:27], v[56:59], v[72:75], v[24:27]
    v_mfma_f32_16x16x32_bf16 v[28:31], v[40:43], v[84:87], v[28:31]
    v_mfma_f32_16x16x32_bf16 v[28:31], v[44:47], v[80:83], v[28:31]
    v_mfma_f32_16x16x32_bf16 v[28:31], v[48:51], v[76:79], v[28:31]
    v_mfma_f32_16x16x32_bf16 v[28:31], v[52:55], v[72:75], v[28:31]
    v_mfma_f32_16x16x32_bf16 v[32:35], v[40:43], v[80:83], v[32:35]
    v_mfma_f32_16x16x32_bf16 v[32:35], v[44:47], v[76:79], v[32:35]
    v_mfma_f32_16x16x32_bf16 v[32:35], v[48:51], v[72:75], v[32:35]
    s_waitcnt lgkmcnt(0)
    v_mfma_f32_16x16x32_bf16 v[20:23], v[104:107], v[156:159], v[20:23]
    ds_read_b64 v[40:41], v4 offset:3776
    ds_read_b64 v[42:43], v4 offset:3784
    v_mfma_f32_16x16x32_bf16 v[20:23], v[108:111], v[152:155], v[20:23]
    ds_read_b128 v[92:95], v5 offset:2752
    ds_read_b64 v[44:45], v4 offset:3264
    v_mfma_f32_16x16x32_bf16 v[20:23], v[112:115], v[148:151], v[20:23]
    ds_read_b64 v[46:47], v4 offset:3272
    ds_read_b128 v[88:91], v5 offset:2240
    v_mfma_f32_16x16x32_bf16 v[20:23], v[116:119], v[144:147], v[20:23]
    ds_read_b64 v[48:49], v4 offset:2752
    ds_read_b64 v[50:51], v4 offset:2760
    v_mfma_f32_16x16x32_bf16 v[20:23], v[120:123], v[140:143], v[20:23]
    ds_read_b128 v[84:87], v5 offset:1728
    ds_read_b64 v[52:53], v4 offset:2240
    v_mfma_f32_16x16x32_bf16 v[20:23], v[124:127], v[136:139], v[20:23]
    ds_read_b64 v[54:55], v4 offset:2248
    ds_read_b128 v[80:83], v5 offset:1216
    v_mfma_f32_16x16x32_bf16 v[24:27], v[104:107], v[152:155], v[24:27]
    ds_read_b64 v[56:57], v4 offset:1728
    ds_read_b64 v[58:59], v4 offset:1736
    v_mfma_f32_16x16x32_bf16 v[24:27], v[108:111], v[148:151], v[24:27]
    ds_read_b128 v[76:79], v5 offset:704
    ds_read_b64 v[60:61], v4 offset:1216
    v_mfma_f32_16x16x32_bf16 v[24:27], v[112:115], v[144:147], v[24:27]
    ds_read_b64 v[62:63], v4 offset:1224
    ds_read_b128 v[72:75], v5 offset:192
    v_mfma_f32_16x16x32_bf16 v[24:27], v[116:119], v[140:143], v[24:27]
    v_mfma_f32_16x16x32_bf16 v[24:27], v[120:123], v[136:139], v[24:27]
    v_mfma_f32_16x16x32_bf16 v[28:31], v[104:107], v[148:151], v[28:31]
    v_mfma_f32_16x16x32_bf16 v[28:31], v[108:111], v[144:147], v[28:31]
    v_mfma_f32_16x16x32_bf16 v[28:31], v[112:115], v[140:143], v[28:31]
    v_mfma_f32_16x16x32_bf16 v[28:31], v[116:119], v[136:139], v[28:31]
    v_mfma_f32_16x16x32_bf16 v[32:35], v[104:107], v[144:147], v[32:35]
    v_mfma_f32_16x16x32_bf16 v[32:35], v[108:111], v[140:143], v[32:35]
    v_mfma_f32_16x16x32_bf16 v[32:35], v[112:115], v[136:139], v[32:35]
    s_waitcnt lgkmcnt(0)
    v_mfma_f32_16x16x32_bf16 v[20:23], v[40:43], v[92:95], v[20:23]
    ds_read_b64 v[104:105], v4 offset:3712
    ds_read_b64 v[106:107], v4 offset:3720
    v_mfma_f32_16x16x32_bf16 v[20:23], v[44:47], v[88:91], v[20:23]
    ds_read_b128 v[156:159], v5 offset:2688
    ds_read_b64 v[108:109], v4 offset:3200
    v_mfma_f32_16x16x32_bf16 v[20:23], v[48:51], v[84:87], v[20:23]
    ds_read_b64 v[110:111], v4 offset:3208
    ds_read_b128 v[152:155], v5 offset:2176
    v_mfma_f32_16x16x32_bf16 v[20:23], v[52:55], v[80:83], v[20:23]
    ds_read_b64 v[112:113], v4 offset:2688
    ds_read_b64 v[114:115], v4 offset:2696
    v_mfma_f32_16x16x32_bf16 v[20:23], v[56:59], v[76:79], v[20:23]
    ds_read_b128 v[148:151], v5 offset:1664
    ds_read_b64 v[116:117], v4 offset:2176
    v_mfma_f32_16x16x32_bf16 v[20:23], v[60:63], v[72:75], v[20:23]
    ds_read_b64 v[118:119], v4 offset:2184
    ds_read_b128 v[144:147], v5 offset:1152
    v_mfma_f32_16x16x32_bf16 v[24:27], v[40:43], v[88:91], v[24:27]
    ds_read_b64 v[120:121], v4 offset:1664
    ds_read_b64 v[122:123], v4 offset:1672
    v_mfma_f32_16x16x32_bf16 v[24:27], v[44:47], v[84:87], v[24:27]
    ds_read_b128 v[140:143], v5 offset:640
    ds_read_b64 v[124:125], v4 offset:1152
    v_mfma_f32_16x16x32_bf16 v[24:27], v[48:51], v[80:83], v[24:27]
    ds_read_b64 v[126:127], v4 offset:1160
    ds_read_b128 v[136:139], v5 offset:128
    v_mfma_f32_16x16x32_bf16 v[24:27], v[52:55], v[76:79], v[24:27]
    v_mfma_f32_16x16x32_bf16 v[24:27], v[56:59], v[72:75], v[24:27]
    v_mfma_f32_16x16x32_bf16 v[28:31], v[40:43], v[84:87], v[28:31]
    v_mfma_f32_16x16x32_bf16 v[28:31], v[44:47], v[80:83], v[28:31]
    v_mfma_f32_16x16x32_bf16 v[28:31], v[48:51], v[76:79], v[28:31]
    v_mfma_f32_16x16x32_bf16 v[28:31], v[52:55], v[72:75], v[28:31]
    v_mfma_f32_16x16x32_bf16 v[32:35], v[40:43], v[80:83], v[32:35]
    v_mfma_f32_16x16x32_bf16 v[32:35], v[44:47], v[76:79], v[32:35]
    v_mfma_f32_16x16x32_bf16 v[32:35], v[48:51], v[72:75], v[32:35]
    s_waitcnt lgkmcnt(0)
    v_mfma_f32_16x16x32_bf16 v[20:23], v[104:107], v[156:159], v[20:23]
    ds_read_b64 v[40:41], v4 offset:3648
    ds_read_b64 v[42:43], v4 offset:3656
    v_mfma_f32_16x16x32_bf16 v[20:23], v[108:111], v[152:155], v[20:23]
    ds_read_b128 v[92:95], v5 offset:2624
    ds_read_b64 v[44:45], v4 offset:3136
    v_mfma_f32_16x16x32_bf16 v[20:23], v[112:115], v[148:151], v[20:23]
    ds_read_b64 v[46:47], v4 offset:3144
    ds_read_b128 v[88:91], v5 offset:2112
    v_mfma_f32_16x16x32_bf16 v[20:23], v[116:119], v[144:147], v[20:23]
    ds_read_b64 v[48:49], v4 offset:2624
    ds_read_b64 v[50:51], v4 offset:2632
    v_mfma_f32_16x16x32_bf16 v[20:23], v[120:123], v[140:143], v[20:23]
    ds_read_b128 v[84:87], v5 offset:1600
    ds_read_b64 v[52:53], v4 offset:2112
    v_mfma_f32_16x16x32_bf16 v[20:23], v[124:127], v[136:139], v[20:23]
    ds_read_b64 v[54:55], v4 offset:2120
    ds_read_b128 v[80:83], v5 offset:1088
    v_mfma_f32_16x16x32_bf16 v[24:27], v[104:107], v[152:155], v[24:27]
    ds_read_b64 v[56:57], v4 offset:1600
    ds_read_b64 v[58:59], v4 offset:1608
    v_mfma_f32_16x16x32_bf16 v[24:27], v[108:111], v[148:151], v[24:27]
    ds_read_b128 v[76:79], v5 offset:576
    ds_read_b64 v[60:61], v4 offset:1088
    v_mfma_f32_16x16x32_bf16 v[24:27], v[112:115], v[144:147], v[24:27]
    ds_read_b64 v[62:63], v4 offset:1096
    ds_read_b128 v[72:75], v5 offset:64
    v_mfma_f32_16x16x32_bf16 v[24:27], v[116:119], v[140:143], v[24:27]
    v_mfma_f32_16x16x32_bf16 v[24:27], v[120:123], v[136:139], v[24:27]
    v_mfma_f32_16x16x32_bf16 v[28:31], v[104:107], v[148:151], v[28:31]
    v_mfma_f32_16x16x32_bf16 v[28:31], v[108:111], v[144:147], v[28:31]
    v_mfma_f32_16x16x32_bf16 v[28:31], v[112:115], v[140:143], v[28:31]
    v_mfma_f32_16x16x32_bf16 v[28:31], v[116:119], v[136:139], v[28:31]
    v_mfma_f32_16x16x32_bf16 v[32:35], v[104:107], v[144:147], v[32:35]
    v_mfma_f32_16x16x32_bf16 v[32:35], v[108:111], v[140:143], v[32:35]
    v_mfma_f32_16x16x32_bf16 v[32:35], v[112:115], v[136:139], v[32:35]
    s_waitcnt lgkmcnt(0)
    v_mfma_f32_16x16x32_bf16 v[20:23], v[40:43], v[92:95], v[20:23]
    ds_read_b64 v[104:105], v4 offset:3584
    ds_read_b64 v[106:107], v4 offset:3592
    v_mfma_f32_16x16x32_bf16 v[20:23], v[44:47], v[88:91], v[20:23]
    ds_read_b128 v[156:159], v5 offset:2560
    ds_read_b64 v[108:109], v4 offset:3072
    v_mfma_f32_16x16x32_bf16 v[20:23], v[48:51], v[84:87], v[20:23]
    ds_read_b64 v[110:111], v4 offset:3080
    ds_read_b128 v[152:155], v5 offset:2048
    v_mfma_f32_16x16x32_bf16 v[20:23], v[52:55], v[80:83], v[20:23]
    ds_read_b64 v[112:113], v4 offset:2560
    ds_read_b64 v[114:115], v4 offset:2568
    v_mfma_f32_16x16x32_bf16 v[20:23], v[56:59], v[76:79], v[20:23]
    ds_read_b128 v[148:151], v5 offset:1536
    ds_read_b64 v[116:117], v4 offset:2048
    v_mfma_f32_16x16x32_bf16 v[20:23], v[60:63], v[72:75], v[20:23]
    ds_read_b64 v[118:119], v4 offset:2056
    ds_read_b128 v[144:147], v5 offset:1024
    v_mfma_f32_16x16x32_bf16 v[24:27], v[40:43], v[88:91], v[24:27]
    ds_read_b64 v[120:121], v4 offset:1536
    ds_read_b64 v[122:123], v4 offset:1544
    v_mfma_f32_16x16x32_bf16 v[24:27], v[44:47], v[84:87], v[24:27]
    ds_read_b128 v[140:143], v5 offset:512
    ds_read_b64 v[124:125], v4 offset:1024
    v_mfma_f32_16x16x32_bf16 v[24:27], v[48:51], v[80:83], v[24:27]
    ds_read_b64 v[126:127], v4 offset:1032
    ds_read_b128 v[136:139], v5 offset:0
    v_mfma_f32_16x16x32_bf16 v[24:27], v[52:55], v[76:79], v[24:27]
    v_mfma_f32_16x16x32_bf16 v[24:27], v[56:59], v[72:75], v[24:27]
    v_mfma_f32_16x16x32_bf16 v[28:31], v[40:43], v[84:87], v[28:31]
    v_mfma_f32_16x16x32_bf16 v[28:31], v[44:47], v[80:83], v[28:31]
    v_mfma_f32_16x16x32_bf16 v[28:31], v[48:51], v[76:79], v[28:31]
    v_mfma_f32_16x16x32_bf16 v[28:31], v[52:55], v[72:75], v[28:31]
    v_mfma_f32_16x16x32_bf16 v[32:35], v[40:43], v[80:83], v[32:35]
    v_mfma_f32_16x16x32_bf16 v[32:35], v[44:47], v[76:79], v[32:35]
    v_mfma_f32_16x16x32_bf16 v[32:35], v[48:51], v[72:75], v[32:35]
    s_waitcnt lgkmcnt(0)
    v_mfma_f32_16x16x32_bf16 v[20:23], v[104:107], v[156:159], v[20:23]
    v_mfma_f32_16x16x32_bf16 v[20:23], v[108:111], v[152:155], v[20:23]
    v_mfma_f32_16x16x32_bf16 v[20:23], v[112:115], v[148:151], v[20:23]
    v_mfma_f32_16x16x32_bf16 v[20:23], v[116:119], v[144:147], v[20:23]
    v_mfma_f32_16x16x32_bf16 v[20:23], v[120:123], v[140:143], v[20:23]
    v_mfma_f32_16x16x32_bf16 v[20:23], v[124:127], v[136:139], v[20:23]
    v_mfma_f32_16x16x32_bf16 v[24:27], v[104:107], v[152:155], v[24:27]
    v_mfma_f32_16x16x32_bf16 v[24:27], v[108:111], v[148:151], v[24:27]
    v_mfma_f32_16x16x32_bf16 v[24:27], v[112:115], v[144:147], v[24:27]
    v_mfma_f32_16x16x32_bf16 v[24:27], v[116:119], v[140:143], v[24:27]
    v_mfma_f32_16x16x32_bf16 v[24:27], v[120:123], v[136:139], v[24:27]
    v_mfma_f32_16x16x32_bf16 v[28:31], v[104:107], v[148:151], v[28:31]
    v_mfma_f32_16x16x32_bf16 v[28:31], v[108:111], v[144:147], v[28:31]
    v_mfma_f32_16x16x32_bf16 v[28:31], v[112:115], v[140:143], v[28:31]
    v_mfma_f32_16x16x32_bf16 v[28:31], v[116:119], v[136:139], v[28:31]
    v_mfma_f32_16x16x32_bf16 v[32:35], v[104:107], v[144:147], v[32:35]
    v_mfma_f32_16x16x32_bf16 v[32:35], v[108:111], v[140:143], v[32:35]
    v_mfma_f32_16x16x32_bf16 v[32:35], v[112:115], v[136:139], v[32:35]
    v_cvt_pk_bf16_f32 v40, v20, v21
    v_cvt_pk_bf16_f32 v41, v22, v23
    v_cvt_pk_bf16_f32 v42, v24, v25
    v_cvt_pk_bf16_f32 v43, v26, v27
    s_nop 0
    v_cvt_pk_bf16_f32 v44, v28, v29
    v_cvt_pk_bf16_f32 v45, v30, v31
    s_nop 0
    v_cvt_pk_bf16_f32 v46, v32, v33
    v_cvt_pk_bf16_f32 v47, v34, v35
    ds_write2_b32 v6, v40, v41 offset0:0 offset1:2
    ds_write2_b32 v6, v42, v43 offset0:128 offset1:130
    ds_write2_b32 v7, v44, v45 offset0:0 offset1:2
    ds_write2_b32 v7, v46, v47 offset0:128 offset1:130
    s_movk_i32 s15, 5
    s_cmp_eq_u32 s13, 1
    s_cselect_b32 s15, 4, s15
    s_cmp_eq_u32 s13, 2
    s_cselect_b32 s15, 3, s15
    s_cmp_eq_u32 s13, 3
    s_cselect_b32 s15, 2, s15
    s_lshl_b32 s15, s15, 19
    s_lshl_b32 s7, s80, 1
    s_add_u32 s15, s15, s7
    s_add_u32 s15, s15, 1024
    v_lshlrev_b32 v8, 3, v0
    v_lshlrev_b32 v9, 13, v2
    v_add_u32 v10, 4096, v9
    s_mov_b32 s8, 0x05040100
    s_mov_b32 s9, 0x07060302
    s_waitcnt lgkmcnt(0)
    s_barrier
    ds_read_b64 v[48:49], v8 offset:0
    ds_read_b64 v[50:51], v8 offset:17696
    ds_read_b64 v[52:53], v8 offset:35392
    ds_read_b64 v[54:55], v8 offset:53088
    s_waitcnt lgkmcnt(0)
    v_perm_b32 v56, v50, v48, s8
    v_perm_b32 v57, v54, v52, s8
    buffer_store_dwordx2 v[56:57], v9, s[44:47], s15 offen offset:0
    v_perm_b32 v58, v50, v48, s9
    v_perm_b32 v59, v54, v52, s9
    buffer_store_dwordx2 v[58:59], v9, s[44:47], s15 offen offset:2048
    v_perm_b32 v60, v51, v49, s8
    v_perm_b32 v61, v55, v53, s8
    buffer_store_dwordx2 v[60:61], v10, s[44:47], s15 offen offset:0
    v_perm_b32 v62, v51, v49, s9
    v_perm_b32 v63, v55, v53, s9
    buffer_store_dwordx2 v[62:63], v10, s[44:47], s15 offen offset:2048
    s_endpgm
L_kv0:
    v_mov_b32 v64, s64
    v_mov_b32 v65, s64
    v_mov_b32 v66, s64
    v_mov_b32 v67, s64
    v_mov_b32 v68, s64
    v_mov_b32 v69, s64
    v_mov_b32 v70, s64
    v_mov_b32 v71, s64
    v_mov_b32 v72, s64
    v_mov_b32 v73, s64
    v_mov_b32 v74, s64
    v_mov_b32 v75, s64
    v_mov_b32 v76, s64
    v_mov_b32 v77, s64
    v_mov_b32 v78, s64
    v_mov_b32 v79, s64
    v_mov_b32 v80, 0
    v_mov_b32 v81, 0
    v_mov_b32 v82, 0
    v_mov_b32 v83, 0
    v_mov_b32 v84, 0
    v_mov_b32 v85, 0
    v_mov_b32 v86, 0
    v_mov_b32 v87, 0
    v_mov_b32 v88, 0
    v_mov_b32 v89, 0
    v_mov_b32 v90, 0
    v_mov_b32 v91, 0
    v_mov_b32 v92, 0
    v_mov_b32 v93, 0
    v_mov_b32 v94, 0
    v_mov_b32 v95, 0
    v_mov_b32 v96, s64
    v_mov_b32 v97, s64
    v_mov_b32 v98, s64
    v_mov_b32 v99, s64
    v_mov_b32 v100, s64
    v_mov_b32 v101, s64
    v_mov_b32 v102, s64
    v_mov_b32 v103, s64
    v_mov_b32 v104, s64
    v_mov_b32 v105, s64
    v_mov_b32 v106, s64
    v_mov_b32 v107, s64
    v_mov_b32 v108, s64
    v_mov_b32 v109, s64
    v_mov_b32 v110, s64
    v_mov_b32 v111, s64
    v_mov_b32 v112, 0
    v_mov_b32 v113, 0
    v_mov_b32 v114, 0
    v_mov_b32 v115, 0
    v_mov_b32 v116, 0
    v_mov_b32 v117, 0
    v_mov_b32 v118, 0
    v_mov_b32 v119, 0
    v_mov_b32 v120, 0
    v_mov_b32 v121, 0
    v_mov_b32 v122, 0
    v_mov_b32 v123, 0
    v_mov_b32 v124, 0
    v_mov_b32 v125, 0
    v_mov_b32 v126, 0
    v_mov_b32 v127, 0
    s_waitcnt vmcnt(10)
    s_barrier
    ds_read_b128 v[32:35], v10 offset:0
    ds_read_b64_tr_b16 v[40:41], v14 offset:0
    ds_read_b64_tr_b16 v[42:43], v14 offset:1024
    ds_read_b64_tr_b16 v[44:45], v15 offset:0
    ds_read_b64_tr_b16 v[46:47], v15 offset:1024
    ds_read_b128 v[36:39], v10 offset:4096
    ds_read_b128 v[48:51], v11 offset:0
    ds_read_b64_tr_b16 v[56:57], v14 offset:4096
    ds_read_b64_tr_b16 v[58:59], v14 offset:5120
    ds_read_b64_tr_b16 v[60:61], v15 offset:4096
    ds_read_b64_tr_b16 v[62:63], v15 offset:5120
    ds_read_b128 v[52:55], v11 offset:4096
    s_add_u32 s63, s10, 2
    s_and_b32 s63, s63, 7
    s_lshl_b32 s63, s63, 7
    s_add_u32 m0, s60, 32768
    s_nop 0
    buffer_load_dwordx4 v4, s[44:47], s63 offen offset:0 lds
    s_add_u32 s63, s10, 2
    s_and_b32 s63, s63, 7
    s_lshl_b32 s63, s63, 7
    s_add_u32 m0, s60, 32768
    s_nop 0
    buffer_load_dwordx4 v5, s[44:47], s63 offen offset:1024 lds
    s_add_u32 s63, s10, 2
    s_and_b32 s63, s63, 7
    s_lshl_b32 s63, s63, 7
    s_add_u32 m0, s60, 32768
    s_nop 0
    buffer_load_dwordx4 v6, s[44:47], s63 offen offset:2048 lds
    s_add_u32 s63, s10, 2
    s_and_b32 s63, s63, 7
    s_lshl_b32 s63, s63, 7
    s_add_u32 m0, s60, 32768
    s_nop 0
    buffer_load_dwordx4 v7, s[44:47], s63 offen offset:3072 lds
    s_waitcnt lgkmcnt(6)
    v_mfma_f32_32x32x16_bf16 v[64:79], v[32:35], v[40:43], v[64:79]
    s_waitcnt vmcnt(12) lgkmcnt(0)
    s_barrier
    ds_read_b128 v[224:227], v12 offset:0
    ds_read_b64_tr_b16 v[232:233], v14 offset:8192
    v_mfma_f32_32x32x16_bf16 v[80:95], v[32:35], v[44:47], v[80:95]
    s_add_u32 s63, s62, 4
    s_and_b32 s63, s63, 15
    s_mul_i32 s63, s63, 98304
    s_add_u32 m0, s61, 0
    s_nop 0
    buffer_load_dwordx4 v8, s[48:51], s63 offen offset:0 lds
    ds_read_b64_tr_b16 v[234:235], v14 offset:9216
    ds_read_b64_tr_b16 v[236:237], v15 offset:8192
    v_mfma_f32_32x32x16_bf16 v[96:111], v[36:39], v[40:43], v[96:111]
    ds_read_b64_tr_b16 v[238:239], v15 offset:9216
    ds_read_b128 v[228:231], v12 offset:4096
    v_mfma_f32_32x32x16_bf16 v[112:127], v[36:39], v[44:47], v[112:127]
    s_add_u32 s63, s62, 4
    s_and_b32 s63, s63, 15
    s_mul_i32 s63, s63, 98304
    s_add_u32 m0, s61, 0
    s_nop 0
    buffer_load_dwordx4 v9, s[48:51], s63 offen offset:1024 lds
    v_mfma_f32_32x32x16_bf16 v[64:79], v[48:51], v[56:59], v[64:79]
    ds_read_b128 v[32:35], v13 offset:0
    ds_read_b64_tr_b16 v[40:41], v14 offset:12288
    v_mfma_f32_32x32x16_bf16 v[80:95], v[48:51], v[60:63], v[80:95]
    ds_read_b64_tr_b16 v[42:43], v14 offset:13312
    ds_read_b64_tr_b16 v[44:45], v15 offset:12288
    v_mfma_f32_32x32x16_bf16 v[96:111], v[52:55], v[56:59], v[96:111]
    ds_read_b64_tr_b16 v[46:47], v15 offset:13312
    ds_read_b128 v[36:39], v13 offset:4096
    v_mfma_f32_32x32x16_bf16 v[112:127], v[52:55], v[60:63], v[112:127]
    s_waitcnt lgkmcnt(6)
    v_mfma_f32_32x32x16_bf16 v[64:79], v[224:227], v[232:235], v[64:79]
    s_waitcnt vmcnt(8) lgkmcnt(0)
    s_barrier
    ds_read_b128 v[48:51], v10 offset:16384
    ds_read_b64_tr_b16 v[56:57], v14 offset:16384
    v_mfma_f32_32x32x16_bf16 v[80:95], v[224:227], v[236:239], v[80:95]
    s_add_u32 s63, s62, 5
    s_and_b32 s63, s63, 15
    s_mul_i32 s63, s63, 98304
    s_add_u32 m0, s61, 8192
    s_nop 0
    buffer_load_dwordx4 v8, s[48:51], s63 offen offset:0 lds
    ds_read_b64_tr_b16 v[58:59], v14 offset:17408
    ds_read_b64_tr_b16 v[60:61], v15 offset:16384
    v_mfma_f32_32x32x16_bf16 v[96:111], v[228:231], v[232:235], v[96:111]
    ds_read_b64_tr_b16 v[62:63], v15 offset:17408
    ds_read_b128 v[52:55], v10 offset:20480
    v_mfma_f32_32x32x16_bf16 v[112:127], v[228:231], v[236:239], v[112:127]
    s_add_u32 s63, s62, 5
    s_and_b32 s63, s63, 15
    s_mul_i32 s63, s63, 98304
    s_add_u32 m0, s61, 8192
    s_nop 0
    buffer_load_dwordx4 v9, s[48:51], s63 offen offset:1024 lds
    v_mfma_f32_32x32x16_bf16 v[64:79], v[32:35], v[40:43], v[64:79]
    ds_read_b128 v[224:227], v11 offset:16384
    ds_read_b64_tr_b16 v[232:233], v14 offset:20480
    v_mfma_f32_32x32x16_bf16 v[80:95], v[32:35], v[44:47], v[80:95]
    s_add_u32 s63, s10, 3
    s_and_b32 s63, s63, 7
    s_lshl_b32 s63, s63, 7
    s_add_u32 m0, s60, 0
    s_nop 0
    buffer_load_dwordx4 v4, s[44:47], s63 offen offset:0 lds
    ds_read_b64_tr_b16 v[234:235], v14 offset:21504
    ds_read_b64_tr_b16 v[236:237], v15 offset:20480
    v_mfma_f32_32x32x16_bf16 v[96:111], v[36:39], v[40:43], v[96:111]
    ds_read_b64_tr_b16 v[238:239], v15 offset:21504
    ds_read_b128 v[228:231], v11 offset:20480
    v_mfma_f32_32x32x16_bf16 v[112:127], v[36:39], v[44:47], v[112:127]
    s_add_u32 s63, s10, 3
    s_and_b32 s63, s63, 7
    s_lshl_b32 s63, s63, 7
    s_add_u32 m0, s60, 0
    s_nop 0
    buffer_load_dwordx4 v5, s[44:47], s63 offen offset:1024 lds
    s_waitcnt lgkmcnt(6)
    v_mfma_f32_32x32x16_bf16 v[64:79], v[48:51], v[56:59], v[64:79]
    s_waitcnt vmcnt(10) lgkmcnt(0)
    s_barrier
    ds_read_b128 v[32:35], v12 offset:16384
    ds_read_b64_tr_b16 v[40:41], v14 offset:24576
    v_mfma_f32_32x32x16_bf16 v[80:95], v[48:51], v[60:63], v[80:95]
    s_add_u32 s63, s10, 3
    s_and_b32 s63, s63, 7
    s_lshl_b32 s63, s63, 7
    s_add_u32 m0, s60, 0
    s_nop 0
    buffer_load_dwordx4 v6, s[44:47], s63 offen offset:2048 lds
    ds_read_b64_tr_b16 v[42:43], v14 offset:25600
    ds_read_b64_tr_b16 v[44:45], v15 offset:24576
    v_mfma_f32_32x32x16_bf16 v[96:111], v[52:55], v[56:59], v[96:111]
    ds_read_b64_tr_b16 v[46:47], v15 offset:25600
    ds_read_b128 v[36:39], v12 offset:20480
    v_mfma_f32_32x32x16_bf16 v[112:127], v[52:55], v[60:63], v[112:127]
    s_add_u32 s63, s10, 3
    s_and_b32 s63, s63, 7
    s_lshl_b32 s63, s63, 7
    s_add_u32 m0, s60, 0
    s_nop 0
    buffer_load_dwordx4 v7, s[44:47], s63 offen offset:3072 lds
    v_mfma_f32_32x32x16_bf16 v[64:79], v[224:227], v[232:235], v[64:79]
    ds_read_b128 v[48:51], v13 offset:16384
    ds_read_b64_tr_b16 v[56:57], v14 offset:28672
    v_mfma_f32_32x32x16_bf16 v[80:95], v[224:227], v[236:239], v[80:95]
    s_add_u32 s63, s62, 6
    s_and_b32 s63, s63, 15
    s_mul_i32 s63, s63, 98304
    s_add_u32 m0, s61, 16384
    s_nop 0
    buffer_load_dwordx4 v8, s[48:51], s63 offen offset:0 lds
    ds_read_b64_tr_b16 v[58:59], v14 offset:29696
    ds_read_b64_tr_b16 v[60:61], v15 offset:28672
    v_mfma_f32_32x32x16_bf16 v[96:111], v[228:231], v[232:235], v[96:111]
    ds_read_b64_tr_b16 v[62:63], v15 offset:29696
    ds_read_b128 v[52:55], v13 offset:20480
    v_mfma_f32_32x32x16_bf16 v[112:127], v[228:231], v[236:239], v[112:127]
    s_add_u32 s63, s62, 6
    s_and_b32 s63, s63, 15
    s_mul_i32 s63, s63, 98304
    s_add_u32 m0, s61, 16384
    s_nop 0
    buffer_load_dwordx4 v9, s[48:51], s63 offen offset:1024 lds
    s_waitcnt lgkmcnt(6)
    v_mfma_f32_32x32x16_bf16 v[64:79], v[32:35], v[40:43], v[64:79]
    s_waitcnt vmcnt(8) lgkmcnt(0)
    s_barrier
    ds_read_b128 v[224:227], v10 offset:32768
    ds_read_b64_tr_b16 v[232:233], v14 offset:0
    v_mfma_f32_32x32x16_bf16 v[80:95], v[32:35], v[44:47], v[80:95]
    s_add_u32 s63, s62, 7
    s_and_b32 s63, s63, 15
    s_mul_i32 s63, s63, 98304
    s_add_u32 m0, s61, 24576
    s_nop 0
    buffer_load_dwordx4 v8, s[48:51], s63 offen offset:0 lds
    ds_read_b64_tr_b16 v[234:235], v14 offset:1024
    ds_read_b64_tr_b16 v[236:237], v15 offset:0
    v_mfma_f32_32x32x16_bf16 v[96:111], v[36:39], v[40:43], v[96:111]
    ds_read_b64_tr_b16 v[238:239], v15 offset:1024
    ds_read_b128 v[228:231], v10 offset:36864
    v_mfma_f32_32x32x16_bf16 v[112:127], v[36:39], v[44:47], v[112:127]
    s_add_u32 s63, s62, 7
    s_and_b32 s63, s63, 15
    s_mul_i32 s63, s63, 98304
    s_add_u32 m0, s61, 24576
    s_nop 0
    buffer_load_dwordx4 v9, s[48:51], s63 offen offset:1024 lds
    v_mfma_f32_32x32x16_bf16 v[64:79], v[48:51], v[56:59], v[64:79]
    ds_read_b128 v[32:35], v11 offset:32768
    ds_read_b64_tr_b16 v[40:41], v14 offset:4096
    v_mfma_f32_32x32x16_bf16 v[80:95], v[48:51], v[60:63], v[80:95]
    s_add_u32 s63, s10, 4
    s_and_b32 s63, s63, 7
    s_lshl_b32 s63, s63, 7
    s_add_u32 m0, s60, 16384
    s_nop 0
    buffer_load_dwordx4 v4, s[44:47], s63 offen offset:0 lds
    ds_read_b64_tr_b16 v[42:43], v14 offset:5120
    ds_read_b64_tr_b16 v[44:45], v15 offset:4096
    v_mfma_f32_32x32x16_bf16 v[96:111], v[52:55], v[56:59], v[96:111]
    ds_read_b64_tr_b16 v[46:47], v15 offset:5120
    ds_read_b128 v[36:39], v11 offset:36864
    v_mfma_f32_32x32x16_bf16 v[112:127], v[52:55], v[60:63], v[112:127]
    s_add_u32 s63, s10, 4
    s_and_b32 s63, s63, 7
    s_lshl_b32 s63, s63, 7
    s_add_u32 m0, s60, 16384
    s_nop 0
    buffer_load_dwordx4 v5, s[44:47], s63 offen offset:1024 lds
    s_waitcnt lgkmcnt(6)
    v_mfma_f32_32x32x16_bf16 v[64:79], v[224:227], v[232:235], v[64:79]
    s_waitcnt vmcnt(10) lgkmcnt(0)
    s_barrier
    ds_read_b128 v[48:51], v12 offset:32768
    ds_read_b64_tr_b16 v[56:57], v14 offset:8192
    v_mfma_f32_32x32x16_bf16 v[80:95], v[224:227], v[236:239], v[80:95]
    s_add_u32 s63, s10, 4
    s_and_b32 s63, s63, 7
    s_lshl_b32 s63, s63, 7
    s_add_u32 m0, s60, 16384
    s_nop 0
    buffer_load_dwordx4 v6, s[44:47], s63 offen offset:2048 lds
    ds_read_b64_tr_b16 v[58:59], v14 offset:9216
    ds_read_b64_tr_b16 v[60:61], v15 offset:8192
    v_mfma_f32_32x32x16_bf16 v[96:111], v[228:231], v[232:235], v[96:111]
    ds_read_b64_tr_b16 v[62:63], v15 offset:9216
    ds_read_b128 v[52:55], v12 offset:36864
    v_mfma_f32_32x32x16_bf16 v[112:127], v[228:231], v[236:239], v[112:127]
    s_add_u32 s63, s10, 4
    s_and_b32 s63, s63, 7
    s_lshl_b32 s63, s63, 7
    s_add_u32 m0, s60, 16384
    s_nop 0
    buffer_load_dwordx4 v7, s[44:47], s63 offen offset:3072 lds
    v_mfma_f32_32x32x16_bf16 v[64:79], v[32:35], v[40:43], v[64:79]
    ds_read_b128 v[224:227], v13 offset:32768
    ds_read_b64_tr_b16 v[232:233], v14 offset:12288
    v_mfma_f32_32x32x16_bf16 v[80:95], v[32:35], v[44:47], v[80:95]
    s_add_u32 s63, s62, 8
    s_and_b32 s63, s63, 15
    s_mul_i32 s63, s63, 98304
    s_add_u32 m0, s61, 0
    s_nop 0
    buffer_load_dwordx4 v8, s[48:51], s63 offen offset:0 lds
    ds_read_b64_tr_b16 v[234:235], v14 offset:13312
    ds_read_b64_tr_b16 v[236:237], v15 offset:12288
    v_mfma_f32_32x32x16_bf16 v[96:111], v[36:39], v[40:43], v[96:111]
    ds_read_b64_tr_b16 v[238:239], v15 offset:13312
    ds_read_b128 v[228:231], v13 offset:36864
    v_mfma_f32_32x32x16_bf16 v[112:127], v[36:39], v[44:47], v[112:127]
    s_add_u32 s63, s62, 8
    s_and_b32 s63, s63, 15
    s_mul_i32 s63, s63, 98304
    s_add_u32 m0, s61, 0
    s_nop 0
    buffer_load_dwordx4 v9, s[48:51], s63 offen offset:1024 lds
    s_waitcnt lgkmcnt(6)
    v_mfma_f32_32x32x16_bf16 v[64:79], v[48:51], v[56:59], v[64:79]
    s_waitcnt vmcnt(8) lgkmcnt(0)
    s_barrier
    ds_read_b128 v[32:35], v10 offset:0
    ds_read_b64_tr_b16 v[40:41], v14 offset:16384
    v_mfma_f32_32x32x16_bf16 v[80:95], v[48:51], v[60:63], v[80:95]
    s_add_u32 s63, s62, 9
    s_and_b32 s63, s63, 15
    s_mul_i32 s63, s63, 98304
    s_add_u32 m0, s61, 8192
    s_nop 0
    buffer_load_dwordx4 v8, s[48:51], s63 offen offset:0 lds
    ds_read_b64_tr_b16 v[42:43], v14 offset:17408
    ds_read_b64_tr_b16 v[44:45], v15 offset:16384
    v_mfma_f32_32x32x16_bf16 v[96:111], v[52:55], v[56:59], v[96:111]
    ds_read_b64_tr_b16 v[46:47], v15 offset:17408
    ds_read_b128 v[36:39], v10 offset:4096
    v_mfma_f32_32x32x16_bf16 v[112:127], v[52:55], v[60:63], v[112:127]
    s_add_u32 s63, s62, 9
    s_and_b32 s63, s63, 15
    s_mul_i32 s63, s63, 98304
    s_add_u32 m0, s61, 8192
    s_nop 0
    buffer_load_dwordx4 v9, s[48:51], s63 offen offset:1024 lds
    v_mfma_f32_32x32x16_bf16 v[64:79], v[224:227], v[232:235], v[64:79]
    ds_read_b128 v[48:51], v11 offset:0
    ds_read_b64_tr_b16 v[56:57], v14 offset:20480
    v_mfma_f32_32x32x16_bf16 v[80:95], v[224:227], v[236:239], v[80:95]
    s_add_u32 s63, s10, 5
    s_and_b32 s63, s63, 7
    s_lshl_b32 s63, s63, 7
    s_add_u32 m0, s60, 32768
    s_nop 0
    buffer_load_dwordx4 v4, s[44:47], s63 offen offset:0 lds
    ds_read_b64_tr_b16 v[58:59], v14 offset:21504
    ds_read_b64_tr_b16 v[60:61], v15 offset:20480
    v_mfma_f32_32x32x16_bf16 v[96:111], v[228:231], v[232:235], v[96:111]
    ds_read_b64_tr_b16 v[62:63], v15 offset:21504
    ds_read_b128 v[52:55], v11 offset:4096
    v_mfma_f32_32x32x16_bf16 v[112:127], v[228:231], v[236:239], v[112:127]
    s_add_u32 s63, s10, 5
    s_and_b32 s63, s63, 7
    s_lshl_b32 s63, s63, 7
    s_add_u32 m0, s60, 32768
    s_nop 0
    buffer_load_dwordx4 v5, s[44:47], s63 offen offset:1024 lds
    s_waitcnt lgkmcnt(6)
    v_mfma_f32_32x32x16_bf16 v[64:79], v[32:35], v[40:43], v[64:79]
    s_waitcnt vmcnt(10) lgkmcnt(0)
    s_barrier
    ds_read_b128 v[224:227], v12 offset:0
    ds_read_b64_tr_b16 v[232:233], v14 offset:24576
    v_mfma_f32_32x32x16_bf16 v[80:95], v[32:35], v[44:47], v[80:95]
    s_add_u32 s63, s10, 5
    s_and_b32 s63, s63, 7
    s_lshl_b32 s63, s63, 7
    s_add_u32 m0, s60, 32768
    s_nop 0
    buffer_load_dwordx4 v6, s[44:47], s63 offen offset:2048 lds
    ds_read_b64_tr_b16 v[234:235], v14 offset:25600
    ds_read_b64_tr_b16 v[236:237], v15 offset:24576
    v_mfma_f32_32x32x16_bf16 v[96:111], v[36:39], v[40:43], v[96:111]
    ds_read_b64_tr_b16 v[238:239], v15 offset:25600
    ds_read_b128 v[228:231], v12 offset:4096
    v_mfma_f32_32x32x16_bf16 v[112:127], v[36:39], v[44:47], v[112:127]
    s_add_u32 s63, s10, 5
    s_and_b32 s63, s63, 7
    s_lshl_b32 s63, s63, 7
    s_add_u32 m0, s60, 32768
    s_nop 0
    buffer_load_dwordx4 v7, s[44:47], s63 offen offset:3072 lds
    v_mfma_f32_32x32x16_bf16 v[64:79], v[48:51], v[56:59], v[64:79]
    ds_read_b128 v[32:35], v13 offset:0
    ds_read_b64_tr_b16 v[40:41], v14 offset:28672
    v_mfma_f32_32x32x16_bf16 v[80:95], v[48:51], v[60:63], v[80:95]
    s_add_u32 s63, s62, 10
    s_and_b32 s63, s63, 15
    s_mul_i32 s63, s63, 98304
    s_add_u32 m0, s61, 16384
    s_nop 0
    buffer_load_dwordx4 v8, s[48:51], s63 offen offset:0 lds
    ds_read_b64_tr_b16 v[42:43], v14 offset:29696
    ds_read_b64_tr_b16 v[44:45], v15 offset:28672
    v_mfma_f32_32x32x16_bf16 v[96:111], v[52:55], v[56:59], v[96:111]
    ds_read_b64_tr_b16 v[46:47], v15 offset:29696
    ds_read_b128 v[36:39], v13 offset:4096
    v_mfma_f32_32x32x16_bf16 v[112:127], v[52:55], v[60:63], v[112:127]
    s_add_u32 s63, s62, 10
    s_and_b32 s63, s63, 15
    s_mul_i32 s63, s63, 98304
    s_add_u32 m0, s61, 16384
    s_nop 0
    buffer_load_dwordx4 v9, s[48:51], s63 offen offset:1024 lds
    s_waitcnt lgkmcnt(6)
    v_mfma_f32_32x32x16_bf16 v[64:79], v[224:227], v[232:235], v[64:79]
    s_waitcnt vmcnt(8) lgkmcnt(0)
    s_barrier
    ds_read_b128 v[48:51], v10 offset:16384
    ds_read_b64_tr_b16 v[56:57], v14 offset:0
    v_mfma_f32_32x32x16_bf16 v[80:95], v[224:227], v[236:239], v[80:95]
    s_add_u32 s63, s62, 11
    s_and_b32 s63, s63, 15
    s_mul_i32 s63, s63, 98304
    s_add_u32 m0, s61, 24576
    s_nop 0
    buffer_load_dwordx4 v8, s[48:51], s63 offen offset:0 lds
    ds_read_b64_tr_b16 v[58:59], v14 offset:1024
    ds_read_b64_tr_b16 v[60:61], v15 offset:0
    v_mfma_f32_32x32x16_bf16 v[96:111], v[228:231], v[232:235], v[96:111]
    ds_read_b64_tr_b16 v[62:63], v15 offset:1024
    ds_read_b128 v[52:55], v10 offset:20480
    v_mfma_f32_32x32x16_bf16 v[112:127], v[228:231], v[236:239], v[112:127]
    s_add_u32 s63, s62, 11
    s_and_b32 s63, s63, 15
    s_mul_i32 s63, s63, 98304
    s_add_u32 m0, s61, 24576
    s_nop 0
    buffer_load_dwordx4 v9, s[48:51], s63 offen offset:1024 lds
    v_mfma_f32_32x32x16_bf16 v[64:79], v[32:35], v[40:43], v[64:79]
    ds_read_b128 v[224:227], v11 offset:16384
    ds_read_b64_tr_b16 v[232:233], v14 offset:4096
    v_mfma_f32_32x32x16_bf16 v[80:95], v[32:35], v[44:47], v[80:95]
    s_add_u32 s63, s10, 6
    s_and_b32 s63, s63, 7
    s_lshl_b32 s63, s63, 7
    s_add_u32 m0, s60, 0
    s_nop 0
    buffer_load_dwordx4 v4, s[44:47], s63 offen offset:0 lds
    ds_read_b64_tr_b16 v[234:235], v14 offset:5120
    ds_read_b64_tr_b16 v[236:237], v15 offset:4096
    v_mfma_f32_32x32x16_bf16 v[96:111], v[36:39], v[40:43], v[96:111]
    ds_read_b64_tr_b16 v[238:239], v15 offset:5120
    ds_read_b128 v[228:231], v11 offset:20480
    v_mfma_f32_32x32x16_bf16 v[112:127], v[36:39], v[44:47], v[112:127]
    s_add_u32 s63, s10, 6
    s_and_b32 s63, s63, 7
    s_lshl_b32 s63, s63, 7
    s_add_u32 m0, s60, 0
    s_nop 0
    buffer_load_dwordx4 v5, s[44:47], s63 offen offset:1024 lds
    s_waitcnt lgkmcnt(6)
    v_mfma_f32_32x32x16_bf16 v[64:79], v[48:51], v[56:59], v[64:79]
    s_waitcnt vmcnt(10) lgkmcnt(0)
    s_barrier
    ds_read_b128 v[32:35], v12 offset:16384
    ds_read_b64_tr_b16 v[40:41], v14 offset:8192
    v_mfma_f32_32x32x16_bf16 v[80:95], v[48:51], v[60:63], v[80:95]
    s_add_u32 s63, s10, 6
    s_and_b32 s63, s63, 7
    s_lshl_b32 s63, s63, 7
    s_add_u32 m0, s60, 0
    s_nop 0
    buffer_load_dwordx4 v6, s[44:47], s63 offen offset:2048 lds
    ds_read_b64_tr_b16 v[42:43], v14 offset:9216
    ds_read_b64_tr_b16 v[44:45], v15 offset:8192
    v_mfma_f32_32x32x16_bf16 v[96:111], v[52:55], v[56:59], v[96:111]
    ds_read_b64_tr_b16 v[46:47], v15 offset:9216
    ds_read_b128 v[36:39], v12 offset:20480
    v_mfma_f32_32x32x16_bf16 v[112:127], v[52:55], v[60:63], v[112:127]
    s_add_u32 s63, s10, 6
    s_and_b32 s63, s63, 7
    s_lshl_b32 s63, s63, 7
    s_add_u32 m0, s60, 0
    s_nop 0
    buffer_load_dwordx4 v7, s[44:47], s63 offen offset:3072 lds
    v_mfma_f32_32x32x16_bf16 v[64:79], v[224:227], v[232:235], v[64:79]
    ds_read_b128 v[48:51], v13 offset:16384
    ds_read_b64_tr_b16 v[56:57], v14 offset:12288
    v_mfma_f32_32x32x16_bf16 v[80:95], v[224:227], v[236:239], v[80:95]
    s_add_u32 s63, s62, 12
    s_and_b32 s63, s63, 15
    s_mul_i32 s63, s63, 98304
    s_add_u32 m0, s61, 0
    s_nop 0
    buffer_load_dwordx4 v8, s[48:51], s63 offen offset:0 lds
    ds_read_b64_tr_b16 v[58:59], v14 offset:13312
    ds_read_b64_tr_b16 v[60:61], v15 offset:12288
    v_mfma_f32_32x32x16_bf16 v[96:111], v[228:231], v[232:235], v[96:111]
    ds_read_b64_tr_b16 v[62:63], v15 offset:13312
    ds_read_b128 v[52:55], v13 offset:20480
    v_mfma_f32_32x32x16_bf16 v[112:127], v[228:231], v[236:239], v[112:127]
    s_add_u32 s63, s62, 12
    s_and_b32 s63, s63, 15
    s_mul_i32 s63, s63, 98304
    s_add_u32 m0, s61, 0
    s_nop 0
    buffer_load_dwordx4 v9, s[48:51], s63 offen offset:1024 lds
    s_waitcnt lgkmcnt(6)
    v_mfma_f32_32x32x16_bf16 v[64:79], v[32:35], v[40:43], v[64:79]
    s_waitcnt vmcnt(8) lgkmcnt(0)
    s_barrier
    ds_read_b128 v[224:227], v10 offset:32768
    ds_read_b64_tr_b16 v[232:233], v14 offset:16384
    v_mfma_f32_32x32x16_bf16 v[80:95], v[32:35], v[44:47], v[80:95]
    s_add_u32 s63, s62, 13
    s_and_b32 s63, s63, 15
    s_mul_i32 s63, s63, 98304
    s_add_u32 m0, s61, 8192
    s_nop 0
    buffer_load_dwordx4 v8, s[48:51], s63 offen offset:0 lds
    ds_read_b64_tr_b16 v[234:235], v14 offset:17408
    ds_read_b64_tr_b16 v[236:237], v15 offset:16384
    v_mfma_f32_32x32x16_bf16 v[96:111], v[36:39], v[40:43], v[96:111]
    ds_read_b64_tr_b16 v[238:239], v15 offset:17408
    ds_read_b128 v[228:231], v10 offset:36864
    v_mfma_f32_32x32x16_bf16 v[112:127], v[36:39], v[44:47], v[112:127]
    s_add_u32 s63, s62, 13
    s_and_b32 s63, s63, 15
    s_mul_i32 s63, s63, 98304
    s_add_u32 m0, s61, 8192
    s_nop 0
    buffer_load_dwordx4 v9, s[48:51], s63 offen offset:1024 lds
    v_mfma_f32_32x32x16_bf16 v[64:79], v[48:51], v[56:59], v[64:79]
    ds_read_b128 v[32:35], v11 offset:32768
    ds_read_b64_tr_b16 v[40:41], v14 offset:20480
    v_mfma_f32_32x32x16_bf16 v[80:95], v[48:51], v[60:63], v[80:95]
    s_add_u32 s63, s10, 7
    s_and_b32 s63, s63, 7
    s_lshl_b32 s63, s63, 7
    s_add_u32 m0, s60, 16384
    s_nop 0
    buffer_load_dwordx4 v4, s[44:47], s63 offen offset:0 lds
    ds_read_b64_tr_b16 v[42:43], v14 offset:21504
    ds_read_b64_tr_b16 v[44:45], v15 offset:20480
    v_mfma_f32_32x32x16_bf16 v[96:111], v[52:55], v[56:59], v[96:111]
    ds_read_b64_tr_b16 v[46:47], v15 offset:21504
    ds_read_b128 v[36:39], v11 offset:36864
    v_mfma_f32_32x32x16_bf16 v[112:127], v[52:55], v[60:63], v[112:127]
    s_add_u32 s63, s10, 7
    s_and_b32 s63, s63, 7
    s_lshl_b32 s63, s63, 7
    s_add_u32 m0, s60, 16384
    s_nop 0
    buffer_load_dwordx4 v5, s[44:47], s63 offen offset:1024 lds
    s_waitcnt lgkmcnt(6)
    v_mfma_f32_32x32x16_bf16 v[64:79], v[224:227], v[232:235], v[64:79]
    s_waitcnt vmcnt(10) lgkmcnt(0)
    s_barrier
    ds_read_b128 v[48:51], v12 offset:32768
    ds_read_b64_tr_b16 v[56:57], v14 offset:24576
    v_mfma_f32_32x32x16_bf16 v[80:95], v[224:227], v[236:239], v[80:95]
    s_add_u32 s63, s10, 7
    s_and_b32 s63, s63, 7
    s_lshl_b32 s63, s63, 7
    s_add_u32 m0, s60, 16384
    s_nop 0
    buffer_load_dwordx4 v6, s[44:47], s63 offen offset:2048 lds
    ds_read_b64_tr_b16 v[58:59], v14 offset:25600
    ds_read_b64_tr_b16 v[60:61], v15 offset:24576
    v_mfma_f32_32x32x16_bf16 v[96:111], v[228:231], v[232:235], v[96:111]
    ds_read_b64_tr_b16 v[62:63], v15 offset:25600
    ds_read_b128 v[52:55], v12 offset:36864
    v_mfma_f32_32x32x16_bf16 v[112:127], v[228:231], v[236:239], v[112:127]
    s_add_u32 s63, s10, 7
    s_and_b32 s63, s63, 7
    s_lshl_b32 s63, s63, 7
    s_add_u32 m0, s60, 16384
    s_nop 0
    buffer_load_dwordx4 v7, s[44:47], s63 offen offset:3072 lds
    v_mfma_f32_32x32x16_bf16 v[64:79], v[32:35], v[40:43], v[64:79]
    ds_read_b128 v[224:227], v13 offset:32768
    ds_read_b64_tr_b16 v[232:233], v14 offset:28672
    v_mfma_f32_32x32x16_bf16 v[80:95], v[32:35], v[44:47], v[80:95]
    s_add_u32 s63, s62, 14
    s_and_b32 s63, s63, 15
    s_mul_i32 s63, s63, 98304
    s_add_u32 m0, s61, 16384
    s_nop 0
    buffer_load_dwordx4 v8, s[48:51], s63 offen offset:0 lds
    ds_read_b64_tr_b16 v[234:235], v14 offset:29696
    ds_read_b64_tr_b16 v[236:237], v15 offset:28672
    v_mfma_f32_32x32x16_bf16 v[96:111], v[36:39], v[40:43], v[96:111]
    ds_read_b64_tr_b16 v[238:239], v15 offset:29696
    ds_read_b128 v[228:231], v13 offset:36864
    v_mfma_f32_32x32x16_bf16 v[112:127], v[36:39], v[44:47], v[112:127]
    s_add_u32 s63, s62, 14
    s_and_b32 s63, s63, 15
    s_mul_i32 s63, s63, 98304
    s_add_u32 m0, s61, 16384
    s_nop 0
    buffer_load_dwordx4 v9, s[48:51], s63 offen offset:1024 lds
    s_waitcnt lgkmcnt(6)
    v_mfma_f32_32x32x16_bf16 v[64:79], v[48:51], v[56:59], v[64:79]
    s_waitcnt vmcnt(8) lgkmcnt(0)
    s_barrier
    ds_read_b128 v[32:35], v10 offset:0
    ds_read_b64_tr_b16 v[40:41], v14 offset:0
    v_mfma_f32_32x32x16_bf16 v[80:95], v[48:51], v[60:63], v[80:95]
    s_add_u32 s63, s62, 15
    s_and_b32 s63, s63, 15
    s_mul_i32 s63, s63, 98304
    s_add_u32 m0, s61, 24576
    s_nop 0
    buffer_load_dwordx4 v8, s[48:51], s63 offen offset:0 lds
    ds_read_b64_tr_b16 v[42:43], v14 offset:1024
    ds_read_b64_tr_b16 v[44:45], v15 offset:0
    v_mfma_f32_32x32x16_bf16 v[96:111], v[52:55], v[56:59], v[96:111]
    ds_read_b64_tr_b16 v[46:47], v15 offset:1024
    ds_read_b128 v[36:39], v10 offset:4096
    v_mfma_f32_32x32x16_bf16 v[112:127], v[52:55], v[60:63], v[112:127]
    s_add_u32 s63, s62, 15
    s_and_b32 s63, s63, 15
    s_mul_i32 s63, s63, 98304
    s_add_u32 m0, s61, 24576
    s_nop 0
    buffer_load_dwordx4 v9, s[48:51], s63 offen offset:1024 lds
    buffer_load_dwordx2 v[244:245], v21, s[56:59], 0 offen sc1
    v_mfma_f32_32x32x16_bf16 v[64:79], v[224:227], v[232:235], v[64:79]
    ds_read_b128 v[48:51], v11 offset:0
    ds_read_b64_tr_b16 v[56:57], v14 offset:4096
    v_mfma_f32_32x32x16_bf16 v[80:95], v[224:227], v[236:239], v[80:95]
    ds_read_b64_tr_b16 v[58:59], v14 offset:5120
    ds_read_b64_tr_b16 v[60:61], v15 offset:4096
    v_mfma_f32_32x32x16_bf16 v[96:111], v[228:231], v[232:235], v[96:111]
    ds_read_b64_tr_b16 v[62:63], v15 offset:5120
    ds_read_b128 v[52:55], v11 offset:4096
    v_mfma_f32_32x32x16_bf16 v[112:127], v[228:231], v[236:239], v[112:127]
    s_waitcnt lgkmcnt(6)
    v_mfma_f32_32x32x16_bf16 v[64:79], v[32:35], v[40:43], v[64:79]
    s_waitcnt vmcnt(9) lgkmcnt(0)
    s_barrier
    ds_read_b128 v[224:227], v12 offset:0
    ds_read_b64_tr_b16 v[232:233], v14 offset:8192
    v_mfma_f32_32x32x16_bf16 v[80:95], v[32:35], v[44:47], v[80:95]
    ds_read_b64_tr_b16 v[234:235], v14 offset:9216
    ds_read_b64_tr_b16 v[236:237], v15 offset:8192
    v_mfma_f32_32x32x16_bf16 v[96:111], v[36:39], v[40:43], v[96:111]
    ds_read_b64_tr_b16 v[238:239], v15 offset:9216
    ds_read_b128 v[228:231], v12 offset:4096
    v_mfma_f32_32x32x16_bf16 v[112:127], v[36:39], v[44:47], v[112:127]
    v_mfma_f32_32x32x16_bf16 v[64:79], v[48:51], v[56:59], v[64:79]
    ds_read_b128 v[32:35], v13 offset:0
    ds_read_b64_tr_b16 v[40:41], v14 offset:12288
    v_mfma_f32_32x32x16_bf16 v[80:95], v[48:51], v[60:63], v[80:95]
    ds_read_b64_tr_b16 v[42:43], v14 offset:13312
    ds_read_b64_tr_b16 v[44:45], v15 offset:12288
    v_mfma_f32_32x32x16_bf16 v[96:111], v[52:55], v[56:59], v[96:111]
    ds_read_b64_tr_b16 v[46:47], v15 offset:13312
    ds_read_b128 v[36:39], v13 offset:4096
    v_mfma_f32_32x32x16_bf16 v[112:127], v[52:55], v[60:63], v[112:127]
    s_waitcnt lgkmcnt(6)
    v_mfma_f32_32x32x16_bf16 v[64:79], v[224:227], v[232:235], v[64:79]
    s_waitcnt vmcnt(3) lgkmcnt(0)
    s_barrier
    ds_read_b128 v[48:51], v10 offset:16384
    ds_read_b64_tr_b16 v[56:57], v14 offset:16384
    v_mfma_f32_32x32x16_bf16 v[80:95], v[224:227], v[236:239], v[80:95]
    ds_read_b64_tr_b16 v[58:59], v14 offset:17408
    ds_read_b64_tr_b16 v[60:61], v15 offset:16384
    v_mfma_f32_32x32x16_bf16 v[96:111], v[228:231], v[232:235], v[96:111]
    ds_read_b64_tr_b16 v[62:63], v15 offset:17408
    ds_read_b128 v[52:55], v10 offset:20480
    v_mfma_f32_32x32x16_bf16 v[112:127], v[228:231], v[236:239], v[112:127]
    v_mfma_f32_32x32x16_bf16 v[64:79], v[32:35], v[40:43], v[64:79]
    ds_read_b128 v[224:227], v11 offset:16384
    ds_read_b64_tr_b16 v[232:233], v14 offset:20480
    v_mfma_f32_32x32x16_bf16 v[80:95], v[32:35], v[44:47], v[80:95]
    ds_read_b64_tr_b16 v[234:235], v14 offset:21504
    ds_read_b64_tr_b16 v[236:237], v15 offset:20480
    v_mfma_f32_32x32x16_bf16 v[96:111], v[36:39], v[40:43], v[96:111]
    ds_read_b64_tr_b16 v[238:239], v15 offset:21504
    ds_read_b128 v[228:231], v11 offset:20480
    v_mfma_f32_32x32x16_bf16 v[112:127], v[36:39], v[44:47], v[112:127]
    s_waitcnt lgkmcnt(6)
    v_mfma_f32_32x32x16_bf16 v[64:79], v[48:51], v[56:59], v[64:79]
    s_waitcnt vmcnt(1) lgkmcnt(0)
    s_barrier
    ds_read_b128 v[32:35], v12 offset:16384
    ds_read_b64_tr_b16 v[40:41], v14 offset:24576
    v_mfma_f32_32x32x16_bf16 v[80:95], v[48:51], v[60:63], v[80:95]
    ds_read_b64_tr_b16 v[42:43], v14 offset:25600
    ds_read_b64_tr_b16 v[44:45], v15 offset:24576
    v_mfma_f32_32x32x16_bf16 v[96:111], v[52:55], v[56:59], v[96:111]
    ds_read_b64_tr_b16 v[46:47], v15 offset:25600
    ds_read_b128 v[36:39], v12 offset:20480
    v_mfma_f32_32x32x16_bf16 v[112:127], v[52:55], v[60:63], v[112:127]
    v_mfma_f32_32x32x16_bf16 v[64:79], v[224:227], v[232:235], v[64:79]
    ds_read_b128 v[48:51], v13 offset:16384
    ds_read_b64_tr_b16 v[56:57], v14 offset:28672
    v_mfma_f32_32x32x16_bf16 v[80:95], v[224:227], v[236:239], v[80:95]
    ds_read_b64_tr_b16 v[58:59], v14 offset:29696
    ds_read_b64_tr_b16 v[60:61], v15 offset:28672
    v_mfma_f32_32x32x16_bf16 v[96:111], v[228:231], v[232:235], v[96:111]
    ds_read_b64_tr_b16 v[62:63], v15 offset:29696
    ds_read_b128 v[52:55], v13 offset:20480
    v_mfma_f32_32x32x16_bf16 v[112:127], v[228:231], v[236:239], v[112:127]
    s_waitcnt lgkmcnt(6)
    v_mfma_f32_32x32x16_bf16 v[64:79], v[32:35], v[40:43], v[64:79]
    v_mfma_f32_32x32x16_bf16 v[80:95], v[32:35], v[44:47], v[80:95]
    v_mfma_f32_32x32x16_bf16 v[96:111], v[36:39], v[40:43], v[96:111]
    v_mfma_f32_32x32x16_bf16 v[112:127], v[36:39], v[44:47], v[112:127]
    s_waitcnt lgkmcnt(0)
    v_mfma_f32_32x32x16_bf16 v[64:79], v[48:51], v[56:59], v[64:79]
    v_mfma_f32_32x32x16_bf16 v[80:95], v[48:51], v[60:63], v[80:95]
    v_mfma_f32_32x32x16_bf16 v[96:111], v[52:55], v[56:59], v[96:111]
    v_mfma_f32_32x32x16_bf16 v[112:127], v[52:55], v[60:63], v[112:127]
    s_cmp_lg_u32 s13, 0
    s_cbranch_scc1 L_go8
    s_cmp_lg_u32 s82, 0
    s_cbranch_scc1 L_go8
    s_mov_b32 s43, 0
    s_branch L_mc10
L_mp9:
    s_sleep 4
    buffer_load_dwordx2 v[244:245], v21, s[56:59], 0 offen sc1
    s_add_u32 s43, s43, 1
L_mc10:
    s_waitcnt vmcnt(0)
    v_min_u32 v246, v244, v245
    s_nop 0
    v_readfirstlane_b32 s42, v246
    s_nop 3
    s_lshr_b32 s65, s43, 16
    s_or_b32 s42, s42, s65
    s_cmp_eq_u32 s42, 0
    s_cbranch_scc1 L_mp9
L_mx11:
    s_lshl_b32 s42, s2, 7
    s_add_u32 s42, s42, 0x210024
    v_mov_b32 v241, 1
    s_mov_b64 exec, 1
    buffer_store_dword v241, v21, s[52:55], s42 offen sc1
    s_mov_b64 exec, -1
L_go8:
    s_mov_b32 s66, 0x3fb8aa3b
    s_mov_b32 s67, 0x3fb8aa3b
    v_mov_b32 v16, 0xb5c1a2a0
    v_mov_b32 v17, 0xb5c1a2a0
    s_mov_b32 s42, 0x3f803f80
    v_mov_b32 v208, s42
    v_mov_b32 v209, s42
    v_mov_b32 v210, s42
    v_mov_b32 v211, s42
    v_pk_fma_f32 v[128:129], v[64:65], s[66:67], v[16:17]
    v_pk_fma_f32 v[130:131], v[66:67], s[66:67], v[16:17]
    v_pk_fma_f32 v[132:133], v[68:69], s[66:67], v[16:17]
    v_pk_fma_f32 v[134:135], v[70:71], s[66:67], v[16:17]
    v_pk_fma_f32 v[136:137], v[72:73], s[66:67], v[16:17]
    v_pk_fma_f32 v[138:139], v[74:75], s[66:67], v[16:17]
    v_pk_fma_f32 v[140:141], v[76:77], s[66:67], v[16:17]
    v_pk_fma_f32 v[142:143], v[78:79], s[66:67], v[16:17]
    v_exp_f32 v128, v128 clamp
    v_max_f32 v64, s64, v64
    v_exp_f32 v129, v129 clamp
    v_max_f32 v65, s64, v65
    v_exp_f32 v130, v130 clamp
    v_max_f32 v66, s64, v66
    v_exp_f32 v131, v131 clamp
    v_max_f32 v67, s64, v67
    v_exp_f32 v132, v132 clamp
    v_max_f32 v68, s64, v68
    v_exp_f32 v133, v133 clamp
    v_max_f32 v69, s64, v69
    v_exp_f32 v134, v134 clamp
    v_max_f32 v70, s64, v70
    v_exp_f32 v135, v135 clamp
    v_max_f32 v71, s64, v71
    v_exp_f32 v136, v136 clamp
    v_max_f32 v72, s64, v72
    v_exp_f32 v137, v137 clamp
    v_max_f32 v73, s64, v73
    v_exp_f32 v138, v138 clamp
    v_max_f32 v74, s64, v74
    v_exp_f32 v139, v139 clamp
    v_max_f32 v75, s64, v75
    v_exp_f32 v140, v140 clamp
    v_max_f32 v76, s64, v76
    v_exp_f32 v141, v141 clamp
    v_max_f32 v77, s64, v77
    v_exp_f32 v142, v142 clamp
    v_max_f32 v78, s64, v78
    v_exp_f32 v143, v143 clamp
    v_max_f32 v79, s64, v79
    v_pk_add_f32 v[64:65], v[64:65], v[128:129]
    v_pk_add_f32 v[66:67], v[66:67], v[130:131]
    v_pk_add_f32 v[68:69], v[68:69], v[132:133]
    v_pk_add_f32 v[70:71], v[70:71], v[134:135]
    v_pk_add_f32 v[72:73], v[72:73], v[136:137]
    v_pk_add_f32 v[74:75], v[74:75], v[138:139]
    v_pk_add_f32 v[76:77], v[76:77], v[140:141]
    v_pk_add_f32 v[78:79], v[78:79], v[142:143]
    v_cvt_pk_bf16_f32 v144, v64, v65
    v_cvt_pk_bf16_f32 v145, v66, v67
    v_cvt_pk_bf16_f32 v146, v68, v69
    v_cvt_pk_bf16_f32 v147, v70, v71
    v_cvt_pk_bf16_f32 v148, v72, v73
    v_cvt_pk_bf16_f32 v149, v74, v75
    v_cvt_pk_bf16_f32 v150, v76, v77
    v_cvt_pk_bf16_f32 v151, v78, v79
    v_cvt_pk_bf16_f32 v152, v80, v81
    v_cvt_pk_bf16_f32 v153, v82, v83
    v_cvt_pk_bf16_f32 v154, v84, v85
    v_cvt_pk_bf16_f32 v155, v86, v87
    v_cvt_pk_bf16_f32 v156, v88, v89
    v_cvt_pk_bf16_f32 v157, v90, v91
    v_cvt_pk_bf16_f32 v158, v92, v93
    v_cvt_pk_bf16_f32 v159, v94, v95
    v_pk_fma_f32 v[128:129], v[96:97], s[66:67], v[16:17]
    v_pk_fma_f32 v[130:131], v[98:99], s[66:67], v[16:17]
    v_pk_fma_f32 v[132:133], v[100:101], s[66:67], v[16:17]
    v_pk_fma_f32 v[134:135], v[102:103], s[66:67], v[16:17]
    v_pk_fma_f32 v[136:137], v[104:105], s[66:67], v[16:17]
    v_pk_fma_f32 v[138:139], v[106:107], s[66:67], v[16:17]
    v_pk_fma_f32 v[140:141], v[108:109], s[66:67], v[16:17]
    v_pk_fma_f32 v[142:143], v[110:111], s[66:67], v[16:17]
    v_exp_f32 v128, v128 clamp
    v_mfma_f32_32x32x16_bf16 v[176:191], v[144:147], v[152:155], 0
    v_max_f32 v96, s64, v96
    v_exp_f32 v129, v129 clamp
    v_max_f32 v97, s64, v97
    v_exp_f32 v130, v130 clamp
    v_max_f32 v98, s64, v98
    v_exp_f32 v131, v131 clamp
    v_max_f32 v99, s64, v99
    v_exp_f32 v132, v132 clamp
    v_mfma_f32_32x32x16_bf16 v[192:207], v[208:211], v[144:147], 0
    v_max_f32 v100, s64, v100
    v_exp_f32 v133, v133 clamp
    v_max_f32 v101, s64, v101
    v_exp_f32 v134, v134 clamp
    v_max_f32 v102, s64, v102
    v_exp_f32 v135, v135 clamp
    v_max_f32 v103, s64, v103
    v_exp_f32 v136, v136 clamp
    v_mfma_f32_32x32x16_bf16 v[176:191], v[148:151], v[156:159], v[176:191]
    v_max_f32 v104, s64, v104
    v_exp_f32 v137, v137 clamp
    v_max_f32 v105, s64, v105
    v_exp_f32 v138, v138 clamp
    v_max_f32 v106, s64, v106
    v_exp_f32 v139, v139 clamp
    v_max_f32 v107, s64, v107
    v_exp_f32 v140, v140 clamp
    v_mfma_f32_32x32x16_bf16 v[192:207], v[208:211], v[148:151], v[192:207]
    v_max_f32 v108, s64, v108
    v_exp_f32 v141, v141 clamp
    v_max_f32 v109, s64, v109
    v_exp_f32 v142, v142 clamp
    v_max_f32 v110, s64, v110
    v_exp_f32 v143, v143 clamp
    v_max_f32 v111, s64, v111
    v_pk_add_f32 v[96:97], v[96:97], v[128:129]
    v_pk_add_f32 v[98:99], v[98:99], v[130:131]
    v_pk_add_f32 v[100:101], v[100:101], v[132:133]
    v_pk_add_f32 v[102:103], v[102:103], v[134:135]
    v_pk_add_f32 v[104:105], v[104:105], v[136:137]
    v_pk_add_f32 v[106:107], v[106:107], v[138:139]
    v_pk_add_f32 v[108:109], v[108:109], v[140:141]
    v_pk_add_f32 v[110:111], v[110:111], v[142:143]
    v_cvt_pk_bf16_f32 v160, v96, v97
    v_cvt_pk_bf16_f32 v161, v98, v99
    v_cvt_pk_bf16_f32 v162, v100, v101
    v_cvt_pk_bf16_f32 v163, v102, v103
    v_cvt_pk_bf16_f32 v164, v104, v105
    v_cvt_pk_bf16_f32 v165, v106, v107
    v_cvt_pk_bf16_f32 v166, v108, v109
    v_cvt_pk_bf16_f32 v167, v110, v111
    v_cvt_pk_bf16_f32 v168, v112, v113
    v_cvt_pk_bf16_f32 v169, v114, v115
    v_cvt_pk_bf16_f32 v170, v116, v117
    v_cvt_pk_bf16_f32 v171, v118, v119
    v_cvt_pk_bf16_f32 v172, v120, v121
    v_cvt_pk_bf16_f32 v173, v122, v123
    v_cvt_pk_bf16_f32 v174, v124, v125
    v_cvt_pk_bf16_f32 v175, v126, v127
    v_mfma_f32_32x32x16_bf16 v[176:191], v[160:163], v[168:171], v[176:191]
    v_mfma_f32_32x32x16_bf16 v[192:207], v[208:211], v[160:163], v[192:207]
    v_mfma_f32_32x32x16_bf16 v[176:191], v[164:167], v[172:175], v[176:191]
    v_mfma_f32_32x32x16_bf16 v[192:207], v[208:211], v[164:167], v[192:207]
    s_mov_b32 s42, 0xffff0000
    s_mov_b32 s43, 0xffff0000
    s_mul_i32 s63, s13, 2304
    s_add_u32 s63, s63, 49152
    v_bfe_u32 v18, v2, 4, 1
    v_lshlrev_b32 v18, 10, v18
    v_lshrrev_b32 v19, 5, v2
    v_lshl_add_u32 v18, v19, 8, v18
    v_and_b32 v19, 15, v2
    v_lshl_add_u32 v18, v19, 4, v18
    v_add_u32 v18, s63, v18
    v_and_b32 v20, 31, v2
    v_lshlrev_b32 v20, 2, v20
    v_add_u32 v20, s63, v20
    v_cndmask_b32 v128, v176, v184, s[42:43]
    v_cndmask_b32 v129, v177, v185, s[42:43]
    v_cndmask_b32 v130, v178, v186, s[42:43]
    v_cndmask_b32 v131, v179, v187, s[42:43]
    v_cndmask_b32 v132, v180, v188, s[42:43]
    v_cndmask_b32 v133, v181, v189, s[42:43]
    v_cndmask_b32 v134, v182, v190, s[42:43]
    v_cndmask_b32 v135, v183, v191, s[42:43]
    ds_write_b128 v18, v[128:131]
    ds_write_b128 v18, v[132:135] offset:512
    ds_write_b32 v20, v192 offset:2048
    s_lshr_b32 s42, s13, 1
    s_and_b32 s43, s13, 1
    s_mul_i32 s63, s43, 2304
    s_add_u32 s63, s63, 49152
    s_lshl_b32 s65, s42, 10
    s_add_u32 s65, s65, s63
    v_lshlrev_b32 v19, 2, v2
    v_add_u32 v20, s65, v19
    s_lshl_b32 s65, s42, 6
    s_add_u32 s65, s65, s63
    v_and_b32 v24, 15, v2
    v_lshlrev_b32 v23, 2, v24
    v_add_u32 v23, s65, v23
    s_lshl_b32 s63, s14, 2
    s_lshl_b32 s43, s43, 1
    s_add_u32 s63, s63, s43
    s_add_u32 s63, s63, s42
    s_mul_i32 s63, s63, 1152
    s_add_u32 s63, s63, 0x230000
    v_lshlrev_b32 v34, 2, v24
    s_mov_b32 s43, 0
    s_branch L_mc13
L_mp12:
    s_sleep 4
    buffer_load_dwordx2 v[244:245], v21, s[56:59], 0 offen sc1
    s_add_u32 s43, s43, 1
L_mc13:
    s_waitcnt vmcnt(0)
    v_min_u32 v246, v244, v245
    s_nop 0
    v_readfirstlane_b32 s42, v246
    s_nop 3
    s_lshr_b32 s65, s43, 16
    s_or_b32 s42, s42, s65
    s_cmp_eq_u32 s42, 0
    s_cbranch_scc1 L_mp12
L_mx14:
    s_waitcnt lgkmcnt(0)
    s_barrier
    ds_read_b32 v24, v20 offset:0
    ds_read_b32 v28, v20 offset:4608
    ds_read_b32 v25, v20 offset:256
    ds_read_b32 v29, v20 offset:4864
    ds_read_b32 v26, v20 offset:512
    ds_read_b32 v30, v20 offset:5120
    ds_read_b32 v27, v20 offset:768
    ds_read_b32 v31, v20 offset:5376
    ds_read_b32 v32, v23 offset:2048
    ds_read_b32 v33, v23 offset:6656
    s_waitcnt lgkmcnt(8)
    v_add_f32 v24, v24, v28
    buffer_atomic_add_f32 v24, v19, s[52:55], s63 offen offset:0
    s_waitcnt lgkmcnt(6)
    v_add_f32 v25, v25, v29
    buffer_atomic_add_f32 v25, v19, s[52:55], s63 offen offset:256
    s_waitcnt lgkmcnt(4)
    v_add_f32 v26, v26, v30
    buffer_atomic_add_f32 v26, v19, s[52:55], s63 offen offset:512
    s_waitcnt lgkmcnt(2)
    v_add_f32 v27, v27, v31
    buffer_atomic_add_f32 v27, v19, s[52:55], s63 offen offset:768
    s_waitcnt lgkmcnt(0)
    v_add_f32 v32, v32, v33
    s_mov_b64 exec, 0xffff
    buffer_atomic_add_f32 v32, v34, s[52:55], s63 offen offset:1024
    s_mov_b64 exec, -1
    s_lshl_b32 s63, s14, 7
    s_add_u32 s63, s63, 0x239000
    v_lshlrev_b32 v17, 10, v2
    v_mov_b32 v16, 1
    s_waitcnt vmcnt(0)
    s_barrier
    s_cmp_lg_u32 s13, 0
    s_cbranch_scc1 L_kva_nf
    s_mov_b32 exec_lo, 0xff
    s_mov_b32 exec_hi, 0x0
    buffer_atomic_add v16, v17, s[52:55], s63 offen sc1
    s_mov_b64 exec, -1
L_kva_nf:
L_g2_entry:
    s_and_b32 s3, s2, 7
    s_lshr_b32 s4, s2, 3
    s_and_b32 s5, s4, 3
    s_lshl_b32 s3, s3, 2
    s_add_u32 s3, s3, s5
    s_lshr_b32 s4, s4, 2
    s_and_b32 s5, s13, 1
    s_lshr_b32 s6, s13, 1
    v_lshlrev_b32 v3, 4, v0
    v_lshlrev_b32 v4, 4, v2
    s_lshl_b32 s14, s3, 1
    s_add_u32 s14, s14, s5
    s_lshl_b32 s14, s14, 5
    s_lshl_b32 s8, s6, 4
    s_add_u32 s14, s14, s8
    s_lshl_b32 s14, s14, 10
    s_add_u32 s14, s14, 0x1000
    s_lshl_b32 s7, s6, 8
    s_lshl_b32 s8, s5, 5
    s_add_u32 s7, s7, s8
    s_lshl_b32 s7, s7, 10
    s_lshl_b32 s8, s4, 7
    s_add_u32 s7, s7, s8
    v_lshrrev_b32 v8, 3, v2
    v_lshlrev_b32 v8, 10, v8
    v_add_u32 v8, s7, v8
    v_and_b32 v9, 7, v2
    v_bfe_u32 v10, v2, 4, 1
    v_lshlrev_b32 v10, 2, v10
    v_xor_b32 v9, v9, v10
    v_lshl_add_u32 v5, v9, 4, v8
    s_lshl_b32 s8, s6, 13
    s_lshl_b32 s9, s5, 12
    s_add_u32 s9, s9, s8
    s_waitcnt lgkmcnt(0)
    s_mov_b32 s44, s36
    s_mov_b32 s45, s37
    s_mov_b32 s46, 0x400000
    s_mov_b32 s47, 0x00020000
    s_mov_b32 s48, s20
    s_mov_b32 s49, s21
    s_mov_b32 s50, 0x80000
    s_mov_b32 s51, 0x00020000
    s_add_u32 m0, s9, 0
    s_mov_b32 s7, 0
    buffer_load_dwordx4 v5, s[48:51], s7 offen offset:0 lds
    s_mov_b32 s7, 7168
    buffer_load_dwordx4 v5, s[48:51], s7 offen offset:1024 lds
    s_mov_b32 s7, 14336
    buffer_load_dwordx4 v5, s[48:51], s7 offen offset:2048 lds
    s_mov_b32 s7, 21504
    buffer_load_dwordx4 v5, s[48:51], s7 offen offset:3072 lds
    s_add_u32 m0, s9, 16384
    s_mov_b32 s7, 65536
    buffer_load_dwordx4 v5, s[48:51], s7 offen offset:0 lds
    s_mov_b32 s7, 72704
    buffer_load_dwordx4 v5, s[48:51], s7 offen offset:1024 lds
    s_mov_b32 s7, 79872
    buffer_load_dwordx4 v5, s[48:51], s7 offen offset:2048 lds
    s_mov_b32 s7, 87040
    buffer_load_dwordx4 v5, s[48:51], s7 offen offset:3072 lds
    s_add_u32 m0, s9, 32768
    s_mov_b32 s7, 131072
    buffer_load_dwordx4 v5, s[48:51], s7 offen offset:0 lds
    s_mov_b32 s7, 138240
    buffer_load_dwordx4 v5, s[48:51], s7 offen offset:1024 lds
    s_mov_b32 s7, 145408
    buffer_load_dwordx4 v5, s[48:51], s7 offen offset:2048 lds
    s_mov_b32 s7, 152576
    buffer_load_dwordx4 v5, s[48:51], s7 offen offset:3072 lds
    s_add_u32 m0, s9, 49152
    s_mov_b32 s7, 196608
    buffer_load_dwordx4 v5, s[48:51], s7 offen offset:0 lds
    s_mov_b32 s7, 203776
    buffer_load_dwordx4 v5, s[48:51], s7 offen offset:1024 lds
    s_mov_b32 s7, 210944
    buffer_load_dwordx4 v5, s[48:51], s7 offen offset:2048 lds
    s_mov_b32 s7, 218112
    buffer_load_dwordx4 v5, s[48:51], s7 offen offset:3072 lds
    v_bfe_u32 v8, v2, 2, 2
    v_lshrrev_b32 v9, 5, v2
    v_lshl_add_u32 v9, v9, 2, v8
    v_lshlrev_b32 v9, 7, v9
    v_lshrrev_b32 v8, 1, v8
    v_lshl_add_u32 v9, v8, 6, v9
    v_bfe_u32 v8, v2, 4, 1
    v_lshl_add_u32 v9, v8, 5, v9
    v_and_b32 v8, 3, v2
    v_lshl_add_u32 v9, v8, 3, v9
    v_add_u32 v6, s8, v9
    v_xor_b32 v7, 64, v6
    v_lshrrev_b32 v9, 5, v2
    v_and_b32 v8, 15, v2
    v_lshl_add_u32 v8, v9, 4, v8
    v_lshlrev_b32 v8, 4, v8
    v_lshlrev_b32 v9, 4, v9
    v_add_u32 v9, 512, v9
    s_mov_b32 s10, 0xffff0000
    s_mov_b32 s11, 0xffff0000
    v_cndmask_b32 v11, v8, v9, s[10:11]
    s_mul_i32 s60, s6, 18432
    s_add_u32 s60, s60, 0x230000
    v_mov_b32 v13, 0
    v_lshlrev_b32 v14, 2, v2
    v_lshlrev_b32 v15, 3, v2
    s_lshl_b32 s15, s2, 7
    s_add_u32 s15, s15, 0x218000
    s_add_u32 s12, s15, 32
    v_mov_b32 v16, 0
    v_mov_b32 v17, 0
    v_mov_b32 v18, 0
    v_mov_b32 v19, 0
    v_mov_b32 v20, 0
    v_mov_b32 v21, 0
    v_mov_b32 v22, 0
    v_mov_b32 v23, 0
    v_mov_b32 v24, 0
    v_mov_b32 v25, 0
    v_mov_b32 v26, 0
    v_mov_b32 v27, 0
    v_mov_b32 v28, 0
    v_mov_b32 v29, 0
    v_mov_b32 v30, 0
    v_mov_b32 v31, 0
    v_mov_b32 v32, 0
    v_mov_b32 v33, 0
    v_mov_b32 v34, 0
    v_mov_b32 v35, 0
    v_mov_b32 v36, 0
    v_mov_b32 v37, 0
    v_mov_b32 v38, 0
    v_mov_b32 v39, 0
    v_mov_b32 v40, 0
    v_mov_b32 v41, 0
    v_mov_b32 v42, 0
    v_mov_b32 v43, 0
    v_mov_b32 v44, 0
    v_mov_b32 v45, 0
    v_mov_b32 v46, 0
    v_mov_b32 v47, 0
    v_add_u32 v9, 512, v9
    v_cndmask_b32 v11, v8, v9, s[10:11]
    v_add_u32 v8, 512, v8
    v_add_u32 v9, 32, v9
    v_cndmask_b32 v12, v8, v9, s[10:11]
L_g2_nored:
    s_cmp_lg_u32 s13, 0
    s_cbranch_scc1 L_g2_w1
    s_mov_b32 s43, 0
    s_mov_b64 exec, 0xf
    s_branch L_ff16
L_fp15:
    s_sleep 4
L_ff16:
    buffer_load_dword v56, v14, s[52:55], s15 offen sc1
    s_add_u32 s43, s43, 1
    s_waitcnt vmcnt(0)
    v_cmp_eq_u32 vcc, 0, v56
    s_lshr_b32 s42, s43, 16
    s_cmp_lg_u32 s42, 0
    s_cbranch_scc1 L_fd17
    s_nop 1
    s_cmp_eq_u64 vcc, 0
    s_cbranch_scc0 L_fp15
L_fd17:
    s_mov_b64 exec, -1
L_g2_w1:
    s_barrier
    s_add_u32 s7, s14, 0
    buffer_load_dwordx4 v[64:67], v4, s[52:55], s7 offen offset:0
    buffer_load_dwordx4 v[68:71], v4, s[52:55], s7 offen offset:1024
    buffer_load_dwordx4 v[72:75], v4, s[52:55], s7 offen offset:2048
    buffer_load_dwordx4 v[76:79], v4, s[52:55], s7 offen offset:3072
    s_add_u32 s7, s14, 4096
    buffer_load_dwordx4 v[80:83], v4, s[52:55], s7 offen offset:0
    buffer_load_dwordx4 v[84:87], v4, s[52:55], s7 offen offset:1024
    buffer_load_dwordx4 v[88:91], v4, s[52:55], s7 offen offset:2048
    buffer_load_dwordx4 v[92:95], v4, s[52:55], s7 offen offset:3072
    s_add_u32 s7, s14, 8192
    buffer_load_dwordx4 v[96:99], v4, s[52:55], s7 offen offset:0
    buffer_load_dwordx4 v[100:103], v4, s[52:55], s7 offen offset:1024
    buffer_load_dwordx4 v[104:107], v4, s[52:55], s7 offen offset:2048
    buffer_load_dwordx4 v[108:111], v4, s[52:55], s7 offen offset:3072
    s_add_u32 s7, s14, 12288
    buffer_load_dwordx4 v[112:115], v4, s[52:55], s7 offen offset:0
    buffer_load_dwordx4 v[116:119], v4, s[52:55], s7 offen offset:1024
    buffer_load_dwordx4 v[120:123], v4, s[52:55], s7 offen offset:2048
    buffer_load_dwordx4 v[124:127], v4, s[52:55], s7 offen offset:3072
    s_cmp_lg_u32 s13, 0
    s_cbranch_scc1 L_g2_w2
    s_and_b32 s12, s2, 7
    s_lshl_b32 s12, s12, 10
    s_add_u32 s12, s12, 0x239000
    v_lshlrev_b32 v57, 7, v2
    s_mov_b32 s43, 0
    s_mov_b32 exec_lo, 0xff
    s_mov_b32 exec_hi, 0x0
    s_branch L_ff19
L_fp18:
    s_sleep 4
L_ff19:
    buffer_load_dword v56, v57, s[52:55], s12 offen sc1
    s_add_u32 s43, s43, 1
    s_waitcnt vmcnt(0)
    v_cmp_ne_u32 vcc, 16, v56
    s_lshr_b32 s42, s43, 16
    s_cmp_lg_u32 s42, 0
    s_cbranch_scc1 L_fd20
    s_nop 1
    s_cmp_eq_u64 vcc, 0
    s_cbranch_scc0 L_fp18
L_fd20:
    s_mov_b64 exec, -1
L_g2_w2:
    s_waitcnt vmcnt(0)
    s_barrier
    s_mov_b32 s62, 0x1fffff
    s_mov_b32 s63, 0x1fffff
    s_mov_b64 exec, s[62:63]
    buffer_load_dwordx4 v[128:131], v11, s[52:55], s60 offen offset:0
    buffer_load_dwordx4 v[132:135], v12, s[52:55], s60 offen offset:0
    buffer_load_dwordx4 v[136:139], v11, s[52:55], s60 offen offset:1152
    buffer_load_dwordx4 v[140:143], v12, s[52:55], s60 offen offset:1152
    buffer_load_dwordx4 v[144:147], v11, s[52:55], s60 offen offset:2304
    buffer_load_dwordx4 v[148:151], v12, s[52:55], s60 offen offset:2304
    buffer_load_dwordx4 v[152:155], v11, s[52:55], s60 offen offset:3456
    buffer_load_dwordx4 v[156:159], v12, s[52:55], s60 offen offset:3456
    s_mov_b64 exec, -1
    s_add_u32 s60, s60, 4608
    s_mov_b64 exec, s[62:63]
    buffer_load_dwordx4 v[160:163], v11, s[52:55], s60 offen offset:0
    buffer_load_dwordx4 v[164:167], v12, s[52:55], s60 offen offset:0
    buffer_load_dwordx4 v[168:171], v11, s[52:55], s60 offen offset:1152
    buffer_load_dwordx4 v[172:175], v12, s[52:55], s60 offen offset:1152
    buffer_load_dwordx4 v[176:179], v11, s[52:55], s60 offen offset:2304
    buffer_load_dwordx4 v[180:183], v12, s[52:55], s60 offen offset:2304
    buffer_load_dwordx4 v[184:187], v11, s[52:55], s60 offen offset:3456
    buffer_load_dwordx4 v[188:191], v12, s[52:55], s60 offen offset:3456
    s_mov_b64 exec, -1
    v_mov_b32 v240, 0
    v_mov_b32 v241, 0
    v_mov_b32 v242, 0
    v_mov_b32 v243, 0
    v_mov_b32 v244, 0
    v_mov_b32 v245, 0
    v_mov_b32 v246, 0
    v_mov_b32 v247, 0
    v_mov_b32 v248, 0x358637bd
    v_mov_b32 v249, 0
    v_mov_b32 v250, 0
    v_mov_b32 v251, 0
    v_mov_b32 v252, 0
    v_mov_b32 v253, 0
    v_mov_b32 v254, 0
    v_mov_b32 v255, 0
    s_mov_b32 s12, 0x358637bd
    ds_read_b64_tr_b16 v[224:225], v6 offset:0
    ds_read_b64_tr_b16 v[226:227], v6 offset:1024
    ds_read_b64_tr_b16 v[228:229], v7 offset:0
    ds_read_b64_tr_b16 v[230:231], v7 offset:1024
    s_waitcnt vmcnt(14)
    v_cvt_pk_bf16_f32 v128, v128, v129
    v_cvt_pk_bf16_f32 v129, v130, v131
    v_cvt_pk_bf16_f32 v130, v132, v133
    v_cvt_pk_bf16_f32 v131, v134, v135
    s_nop 1
    v_mfma_f32_32x32x16_bf16 v[192:207], v[128:131], v[64:67], v[240:255]
    s_waitcnt vmcnt(12)
    v_cvt_pk_bf16_f32 v136, v136, v137
    v_cvt_pk_bf16_f32 v137, v138, v139
    v_cvt_pk_bf16_f32 v138, v140, v141
    v_cvt_pk_bf16_f32 v139, v142, v143
    s_nop 1
    v_mfma_f32_32x32x16_bf16 v[208:223], v[136:139], v[68:71], v[240:255]
    s_add_u32 s60, s60, 4608
    s_mov_b64 exec, s[62:63]
    buffer_load_dwordx4 v[128:131], v11, s[52:55], s60 offen offset:0
    buffer_load_dwordx4 v[132:135], v12, s[52:55], s60 offen offset:0
    buffer_load_dwordx4 v[136:139], v11, s[52:55], s60 offen offset:1152
    buffer_load_dwordx4 v[140:143], v12, s[52:55], s60 offen offset:1152
    s_mov_b64 exec, -1
    v_rcp_f32 v56, v200
    s_nop 0
    v_mul_f32 v192, v192, v56
    v_mul_f32 v193, v193, v56
    v_cvt_pk_bf16_f32 v48, v192, v193
    v_mul_f32 v194, v194, v56
    v_mul_f32 v195, v195, v56
    v_cvt_pk_bf16_f32 v49, v194, v195
    v_mul_f32 v196, v196, v56
    v_mul_f32 v197, v197, v56
    v_cvt_pk_bf16_f32 v50, v196, v197
    v_mul_f32 v198, v198, v56
    v_mul_f32 v199, v199, v56
    v_cvt_pk_bf16_f32 v51, v198, v199
    ds_read_b64_tr_b16 v[232:233], v6 offset:2048
    ds_read_b64_tr_b16 v[234:235], v6 offset:3072
    ds_read_b64_tr_b16 v[236:237], v7 offset:2048
    ds_read_b64_tr_b16 v[238:239], v7 offset:3072
    s_waitcnt lgkmcnt(4)
    s_waitcnt vmcnt(14)
    v_cvt_pk_bf16_f32 v144, v144, v145
    v_cvt_pk_bf16_f32 v145, v146, v147
    v_cvt_pk_bf16_f32 v146, v148, v149
    v_cvt_pk_bf16_f32 v147, v150, v151
    s_nop 1
    v_mfma_f32_32x32x16_bf16 v[192:207], v[144:147], v[72:75], v[240:255]
    v_rcp_f32 v56, v216
    s_nop 0
    v_mul_f32 v208, v208, v56
    v_mul_f32 v209, v209, v56
    v_cvt_pk_bf16_f32 v52, v208, v209
    v_mfma_f32_32x32x16_bf16 v[16:31], v[224:227], v[48:51], v[16:31]
    v_mul_f32 v210, v210, v56
    v_mul_f32 v211, v211, v56
    v_cvt_pk_bf16_f32 v53, v210, v211
    v_mul_f32 v212, v212, v56
    v_mul_f32 v213, v213, v56
    v_mfma_f32_32x32x16_bf16 v[32:47], v[228:231], v[48:51], v[32:47]
    v_cvt_pk_bf16_f32 v54, v212, v213
    v_mul_f32 v214, v214, v56
    v_mul_f32 v215, v215, v56
    v_cvt_pk_bf16_f32 v55, v214, v215
    ds_read_b64_tr_b16 v[224:225], v6 offset:4096
    ds_read_b64_tr_b16 v[226:227], v6 offset:5120
    ds_read_b64_tr_b16 v[228:229], v7 offset:4096
    ds_read_b64_tr_b16 v[230:231], v7 offset:5120
    s_waitcnt lgkmcnt(4)
    s_waitcnt vmcnt(12)
    v_cvt_pk_bf16_f32 v152, v152, v153
    v_cvt_pk_bf16_f32 v153, v154, v155
    v_cvt_pk_bf16_f32 v154, v156, v157
    v_cvt_pk_bf16_f32 v155, v158, v159
    s_nop 1
    v_mfma_f32_32x32x16_bf16 v[208:223], v[152:155], v[76:79], v[240:255]
    s_mov_b64 exec, s[62:63]
    buffer_load_dwordx4 v[144:147], v11, s[52:55], s60 offen offset:2304
    buffer_load_dwordx4 v[148:151], v12, s[52:55], s60 offen offset:2304
    buffer_load_dwordx4 v[152:155], v11, s[52:55], s60 offen offset:3456
    buffer_load_dwordx4 v[156:159], v12, s[52:55], s60 offen offset:3456
    s_mov_b64 exec, -1
    v_rcp_f32 v56, v200
    s_nop 0
    v_mul_f32 v192, v192, v56
    v_mul_f32 v193, v193, v56
    v_cvt_pk_bf16_f32 v48, v192, v193
    v_mfma_f32_32x32x16_bf16 v[16:31], v[232:235], v[52:55], v[16:31]
    v_mul_f32 v194, v194, v56
    v_mul_f32 v195, v195, v56
    v_cvt_pk_bf16_f32 v49, v194, v195
    v_mul_f32 v196, v196, v56
    v_mul_f32 v197, v197, v56
    v_mfma_f32_32x32x16_bf16 v[32:47], v[236:239], v[52:55], v[32:47]
    v_cvt_pk_bf16_f32 v50, v196, v197
    v_mul_f32 v198, v198, v56
    v_mul_f32 v199, v199, v56
    v_cvt_pk_bf16_f32 v51, v198, v199
    ds_read_b64_tr_b16 v[232:233], v6 offset:6144
    ds_read_b64_tr_b16 v[234:235], v6 offset:7168
    ds_read_b64_tr_b16 v[236:237], v7 offset:6144
    ds_read_b64_tr_b16 v[238:239], v7 offset:7168
    s_waitcnt lgkmcnt(4)
    s_waitcnt vmcnt(14)
    v_cvt_pk_bf16_f32 v160, v160, v161
    v_cvt_pk_bf16_f32 v161, v162, v163
    v_cvt_pk_bf16_f32 v162, v164, v165
    v_cvt_pk_bf16_f32 v163, v166, v167
    s_nop 1
    v_mfma_f32_32x32x16_bf16 v[192:207], v[160:163], v[80:83], v[240:255]
    v_rcp_f32 v56, v216
    s_nop 0
    v_mul_f32 v208, v208, v56
    v_mul_f32 v209, v209, v56
    v_cvt_pk_bf16_f32 v52, v208, v209
    v_mfma_f32_32x32x16_bf16 v[16:31], v[224:227], v[48:51], v[16:31]
    v_mul_f32 v210, v210, v56
    v_mul_f32 v211, v211, v56
    v_cvt_pk_bf16_f32 v53, v210, v211
    v_mul_f32 v212, v212, v56
    v_mul_f32 v213, v213, v56
    v_mfma_f32_32x32x16_bf16 v[32:47], v[228:231], v[48:51], v[32:47]
    v_cvt_pk_bf16_f32 v54, v212, v213
    v_mul_f32 v214, v214, v56
    v_mul_f32 v215, v215, v56
    v_cvt_pk_bf16_f32 v55, v214, v215
    ds_read_b64_tr_b16 v[224:225], v6 offset:16384
    ds_read_b64_tr_b16 v[226:227], v6 offset:17408
    ds_read_b64_tr_b16 v[228:229], v7 offset:16384
    ds_read_b64_tr_b16 v[230:231], v7 offset:17408
    s_waitcnt lgkmcnt(4)
    s_waitcnt vmcnt(12)
    v_cvt_pk_bf16_f32 v168, v168, v169
    v_cvt_pk_bf16_f32 v169, v170, v171
    v_cvt_pk_bf16_f32 v170, v172, v173
    v_cvt_pk_bf16_f32 v171, v174, v175
    s_nop 1
    v_mfma_f32_32x32x16_bf16 v[208:223], v[168:171], v[84:87], v[240:255]
    s_add_u32 s60, s60, 4608
    s_mov_b64 exec, s[62:63]
    buffer_load_dwordx4 v[160:163], v11, s[52:55], s60 offen offset:0
    buffer_load_dwordx4 v[164:167], v12, s[52:55], s60 offen offset:0
    buffer_load_dwordx4 v[168:171], v11, s[52:55], s60 offen offset:1152
    buffer_load_dwordx4 v[172:175], v12, s[52:55], s60 offen offset:1152
    s_mov_b64 exec, -1
    v_rcp_f32 v56, v200
    s_nop 0
    v_mul_f32 v192, v192, v56
    v_mul_f32 v193, v193, v56
    v_cvt_pk_bf16_f32 v48, v192, v193
    v_mfma_f32_32x32x16_bf16 v[16:31], v[232:235], v[52:55], v[16:31]
    v_mul_f32 v194, v194, v56
    v_mul_f32 v195, v195, v56
    v_cvt_pk_bf16_f32 v49, v194, v195
    v_mul_f32 v196, v196, v56
    v_mul_f32 v197, v197, v56
    v_mfma_f32_32x32x16_bf16 v[32:47], v[236:239], v[52:55], v[32:47]
    v_cvt_pk_bf16_f32 v50, v196, v197
    v_mul_f32 v198, v198, v56
    v_mul_f32 v199, v199, v56
    v_cvt_pk_bf16_f32 v51, v198, v199
    ds_read_b64_tr_b16 v[232:233], v6 offset:18432
    ds_read_b64_tr_b16 v[234:235], v6 offset:19456
    ds_read_b64_tr_b16 v[236:237], v7 offset:18432
    ds_read_b64_tr_b16 v[238:239], v7 offset:19456
    s_waitcnt lgkmcnt(4)
    s_waitcnt vmcnt(14)
    v_cvt_pk_bf16_f32 v176, v176, v177
    v_cvt_pk_bf16_f32 v177, v178, v179
    v_cvt_pk_bf16_f32 v178, v180, v181
    v_cvt_pk_bf16_f32 v179, v182, v183
    s_nop 1
    v_mfma_f32_32x32x16_bf16 v[192:207], v[176:179], v[88:91], v[240:255]
    v_rcp_f32 v56, v216
    s_nop 0
    v_mul_f32 v208, v208, v56
    v_mul_f32 v209, v209, v56
    v_cvt_pk_bf16_f32 v52, v208, v209
    v_mfma_f32_32x32x16_bf16 v[16:31], v[224:227], v[48:51], v[16:31]
    v_mul_f32 v210, v210, v56
    v_mul_f32 v211, v211, v56
    v_cvt_pk_bf16_f32 v53, v210, v211
    v_mul_f32 v212, v212, v56
    v_mul_f32 v213, v213, v56
    v_mfma_f32_32x32x16_bf16 v[32:47], v[228:231], v[48:51], v[32:47]
    v_cvt_pk_bf16_f32 v54, v212, v213
    v_mul_f32 v214, v214, v56
    v_mul_f32 v215, v215, v56
    v_cvt_pk_bf16_f32 v55, v214, v215
    ds_read_b64_tr_b16 v[224:225], v6 offset:20480
    ds_read_b64_tr_b16 v[226:227], v6 offset:21504
    ds_read_b64_tr_b16 v[228:229], v7 offset:20480
    ds_read_b64_tr_b16 v[230:231], v7 offset:21504
    s_waitcnt lgkmcnt(4)
    s_waitcnt vmcnt(12)
    v_cvt_pk_bf16_f32 v184, v184, v185
    v_cvt_pk_bf16_f32 v185, v186, v187
    v_cvt_pk_bf16_f32 v186, v188, v189
    v_cvt_pk_bf16_f32 v187, v190, v191
    s_nop 1
    v_mfma_f32_32x32x16_bf16 v[208:223], v[184:187], v[92:95], v[240:255]
    s_mov_b64 exec, s[62:63]
    buffer_load_dwordx4 v[176:179], v11, s[52:55], s60 offen offset:2304
    buffer_load_dwordx4 v[180:183], v12, s[52:55], s60 offen offset:2304
    buffer_load_dwordx4 v[184:187], v11, s[52:55], s60 offen offset:3456
    buffer_load_dwordx4 v[188:191], v12, s[52:55], s60 offen offset:3456
    s_mov_b64 exec, -1
    v_rcp_f32 v56, v200
    s_nop 0
    v_mul_f32 v192, v192, v56
    v_mul_f32 v193, v193, v56
    v_cvt_pk_bf16_f32 v48, v192, v193
    v_mfma_f32_32x32x16_bf16 v[16:31], v[232:235], v[52:55], v[16:31]
    v_mul_f32 v194, v194, v56
    v_mul_f32 v195, v195, v56
    v_cvt_pk_bf16_f32 v49, v194, v195
    v_mul_f32 v196, v196, v56
    v_mul_f32 v197, v197, v56
    v_mfma_f32_32x32x16_bf16 v[32:47], v[236:239], v[52:55], v[32:47]
    v_cvt_pk_bf16_f32 v50, v196, v197
    v_mul_f32 v198, v198, v56
    v_mul_f32 v199, v199, v56
    v_cvt_pk_bf16_f32 v51, v198, v199
    ds_read_b64_tr_b16 v[232:233], v6 offset:22528
    ds_read_b64_tr_b16 v[234:235], v6 offset:23552
    ds_read_b64_tr_b16 v[236:237], v7 offset:22528
    ds_read_b64_tr_b16 v[238:239], v7 offset:23552
    s_waitcnt lgkmcnt(4)
    s_waitcnt vmcnt(14)
    v_cvt_pk_bf16_f32 v128, v128, v129
    v_cvt_pk_bf16_f32 v129, v130, v131
    v_cvt_pk_bf16_f32 v130, v132, v133
    v_cvt_pk_bf16_f32 v131, v134, v135
    s_nop 1
    v_mfma_f32_32x32x16_bf16 v[192:207], v[128:131], v[96:99], v[240:255]
    v_rcp_f32 v56, v216
    s_nop 0
    v_mul_f32 v208, v208, v56
    v_mul_f32 v209, v209, v56
    v_cvt_pk_bf16_f32 v52, v208, v209
    v_mfma_f32_32x32x16_bf16 v[16:31], v[224:227], v[48:51], v[16:31]
    v_mul_f32 v210, v210, v56
    v_mul_f32 v211, v211, v56
    v_cvt_pk_bf16_f32 v53, v210, v211
    v_mul_f32 v212, v212, v56
    v_mul_f32 v213, v213, v56
    v_mfma_f32_32x32x16_bf16 v[32:47], v[228:231], v[48:51], v[32:47]
    v_cvt_pk_bf16_f32 v54, v212, v213
    v_mul_f32 v214, v214, v56
    v_mul_f32 v215, v215, v56
    v_cvt_pk_bf16_f32 v55, v214, v215
    ds_read_b64_tr_b16 v[224:225], v6 offset:32768
    ds_read_b64_tr_b16 v[226:227], v6 offset:33792
    ds_read_b64_tr_b16 v[228:229], v7 offset:32768
    ds_read_b64_tr_b16 v[230:231], v7 offset:33792
    s_waitcnt lgkmcnt(4)
    s_waitcnt vmcnt(12)
    v_cvt_pk_bf16_f32 v136, v136, v137
    v_cvt_pk_bf16_f32 v137, v138, v139
    v_cvt_pk_bf16_f32 v138, v140, v141
    v_cvt_pk_bf16_f32 v139, v142, v143
    s_nop 1
    v_mfma_f32_32x32x16_bf16 v[208:223], v[136:139], v[100:103], v[240:255]
    v_rcp_f32 v56, v200
    s_nop 0
    v_mul_f32 v192, v192, v56
    v_mul_f32 v193, v193, v56
    v_cvt_pk_bf16_f32 v48, v192, v193
    v_mfma_f32_32x32x16_bf16 v[16:31], v[232:235], v[52:55], v[16:31]
    v_mul_f32 v194, v194, v56
    v_mul_f32 v195, v195, v56
    v_cvt_pk_bf16_f32 v49, v194, v195
    v_mul_f32 v196, v196, v56
    v_mul_f32 v197, v197, v56
    v_mfma_f32_32x32x16_bf16 v[32:47], v[236:239], v[52:55], v[32:47]
    v_cvt_pk_bf16_f32 v50, v196, v197
    v_mul_f32 v198, v198, v56
    v_mul_f32 v199, v199, v56
    v_cvt_pk_bf16_f32 v51, v198, v199
    ds_read_b64_tr_b16 v[232:233], v6 offset:34816
    ds_read_b64_tr_b16 v[234:235], v6 offset:35840
    ds_read_b64_tr_b16 v[236:237], v7 offset:34816
    ds_read_b64_tr_b16 v[238:239], v7 offset:35840
    s_waitcnt lgkmcnt(4)
    s_waitcnt vmcnt(10)
    v_cvt_pk_bf16_f32 v144, v144, v145
    v_cvt_pk_bf16_f32 v145, v146, v147
    v_cvt_pk_bf16_f32 v146, v148, v149
    v_cvt_pk_bf16_f32 v147, v150, v151
    s_nop 1
    v_mfma_f32_32x32x16_bf16 v[192:207], v[144:147], v[104:107], v[240:255]
    v_rcp_f32 v56, v216
    s_nop 0
    v_mul_f32 v208, v208, v56
    v_mul_f32 v209, v209, v56
    v_cvt_pk_bf16_f32 v52, v208, v209
    v_mfma_f32_32x32x16_bf16 v[16:31], v[224:227], v[48:51], v[16:31]
    v_mul_f32 v210, v210, v56
    v_mul_f32 v211, v211, v56
    v_cvt_pk_bf16_f32 v53, v210, v211
    v_mul_f32 v212, v212, v56
    v_mul_f32 v213, v213, v56
    v_mfma_f32_32x32x16_bf16 v[32:47], v[228:231], v[48:51], v[32:47]
    v_cvt_pk_bf16_f32 v54, v212, v213
    v_mul_f32 v214, v214, v56
    v_mul_f32 v215, v215, v56
    v_cvt_pk_bf16_f32 v55, v214, v215
    ds_read_b64_tr_b16 v[224:225], v6 offset:36864
    ds_read_b64_tr_b16 v[226:227], v6 offset:37888
    ds_read_b64_tr_b16 v[228:229], v7 offset:36864
    ds_read_b64_tr_b16 v[230:231], v7 offset:37888
    s_waitcnt lgkmcnt(4)
    s_waitcnt vmcnt(8)
    v_cvt_pk_bf16_f32 v152, v152, v153
    v_cvt_pk_bf16_f32 v153, v154, v155
    v_cvt_pk_bf16_f32 v154, v156, v157
    v_cvt_pk_bf16_f32 v155, v158, v159
    s_nop 1
    v_mfma_f32_32x32x16_bf16 v[208:223], v[152:155], v[108:111], v[240:255]
    v_rcp_f32 v56, v200
    s_nop 0
    v_mul_f32 v192, v192, v56
    v_mul_f32 v193, v193, v56
    v_cvt_pk_bf16_f32 v48, v192, v193
    v_mfma_f32_32x32x16_bf16 v[16:31], v[232:235], v[52:55], v[16:31]
    v_mul_f32 v194, v194, v56
    v_mul_f32 v195, v195, v56
    v_cvt_pk_bf16_f32 v49, v194, v195
    v_mul_f32 v196, v196, v56
    v_mul_f32 v197, v197, v56
    v_mfma_f32_32x32x16_bf16 v[32:47], v[236:239], v[52:55], v[32:47]
    v_cvt_pk_bf16_f32 v50, v196, v197
    v_mul_f32 v198, v198, v56
    v_mul_f32 v199, v199, v56
    v_cvt_pk_bf16_f32 v51, v198, v199
    ds_read_b64_tr_b16 v[232:233], v6 offset:38912
    ds_read_b64_tr_b16 v[234:235], v6 offset:39936
    ds_read_b64_tr_b16 v[236:237], v7 offset:38912
    ds_read_b64_tr_b16 v[238:239], v7 offset:39936
    s_waitcnt lgkmcnt(4)
    s_waitcnt vmcnt(6)
    v_cvt_pk_bf16_f32 v160, v160, v161
    v_cvt_pk_bf16_f32 v161, v162, v163
    v_cvt_pk_bf16_f32 v162, v164, v165
    v_cvt_pk_bf16_f32 v163, v166, v167
    s_nop 1
    v_mfma_f32_32x32x16_bf16 v[192:207], v[160:163], v[112:115], v[240:255]
    v_rcp_f32 v56, v216
    s_nop 0
    v_mul_f32 v208, v208, v56
    v_mul_f32 v209, v209, v56
    v_cvt_pk_bf16_f32 v52, v208, v209
    v_mfma_f32_32x32x16_bf16 v[16:31], v[224:227], v[48:51], v[16:31]
    v_mul_f32 v210, v210, v56
    v_mul_f32 v211, v211, v56
    v_cvt_pk_bf16_f32 v53, v210, v211
    v_mul_f32 v212, v212, v56
    v_mul_f32 v213, v213, v56
    v_mfma_f32_32x32x16_bf16 v[32:47], v[228:231], v[48:51], v[32:47]
    v_cvt_pk_bf16_f32 v54, v212, v213
    v_mul_f32 v214, v214, v56
    v_mul_f32 v215, v215, v56
    v_cvt_pk_bf16_f32 v55, v214, v215
    ds_read_b64_tr_b16 v[224:225], v6 offset:49152
    ds_read_b64_tr_b16 v[226:227], v6 offset:50176
    ds_read_b64_tr_b16 v[228:229], v7 offset:49152
    ds_read_b64_tr_b16 v[230:231], v7 offset:50176
    s_waitcnt lgkmcnt(4)
    s_waitcnt vmcnt(4)
    v_cvt_pk_bf16_f32 v168, v168, v169
    v_cvt_pk_bf16_f32 v169, v170, v171
    v_cvt_pk_bf16_f32 v170, v172, v173
    v_cvt_pk_bf16_f32 v171, v174, v175
    s_nop 1
    v_mfma_f32_32x32x16_bf16 v[208:223], v[168:171], v[116:119], v[240:255]
    v_rcp_f32 v56, v200
    s_nop 0
    v_mul_f32 v192, v192, v56
    v_mul_f32 v193, v193, v56
    v_cvt_pk_bf16_f32 v48, v192, v193
    v_mfma_f32_32x32x16_bf16 v[16:31], v[232:235], v[52:55], v[16:31]
    v_mul_f32 v194, v194, v56
    v_mul_f32 v195, v195, v56
    v_cvt_pk_bf16_f32 v49, v194, v195
    v_mul_f32 v196, v196, v56
    v_mul_f32 v197, v197, v56
    v_mfma_f32_32x32x16_bf16 v[32:47], v[236:239], v[52:55], v[32:47]
    v_cvt_pk_bf16_f32 v50, v196, v197
    v_mul_f32 v198, v198, v56
    v_mul_f32 v199, v199, v56
    v_cvt_pk_bf16_f32 v51, v198, v199
    ds_read_b64_tr_b16 v[232:233], v6 offset:51200
    ds_read_b64_tr_b16 v[234:235], v6 offset:52224
    ds_read_b64_tr_b16 v[236:237], v7 offset:51200
    ds_read_b64_tr_b16 v[238:239], v7 offset:52224
    s_waitcnt lgkmcnt(4)
    s_waitcnt vmcnt(2)
    v_cvt_pk_bf16_f32 v176, v176, v177
    v_cvt_pk_bf16_f32 v177, v178, v179
    v_cvt_pk_bf16_f32 v178, v180, v181
    v_cvt_pk_bf16_f32 v179, v182, v183
    s_nop 1
    v_mfma_f32_32x32x16_bf16 v[192:207], v[176:179], v[120:123], v[240:255]
    v_rcp_f32 v56, v216
    s_nop 0
    v_mul_f32 v208, v208, v56
    v_mul_f32 v209, v209, v56
    v_cvt_pk_bf16_f32 v52, v208, v209
    v_mfma_f32_32x32x16_bf16 v[16:31], v[224:227], v[48:51], v[16:31]
    v_mul_f32 v210, v210, v56
    v_mul_f32 v211, v211, v56
    v_cvt_pk_bf16_f32 v53, v210, v211
    v_mul_f32 v212, v212, v56
    v_mul_f32 v213, v213, v56
    v_mfma_f32_32x32x16_bf16 v[32:47], v[228:231], v[48:51], v[32:47]
    v_cvt_pk_bf16_f32 v54, v212, v213
    v_mul_f32 v214, v214, v56
    v_mul_f32 v215, v215, v56
    v_cvt_pk_bf16_f32 v55, v214, v215
    ds_read_b64_tr_b16 v[224:225], v6 offset:53248
    ds_read_b64_tr_b16 v[226:227], v6 offset:54272
    ds_read_b64_tr_b16 v[228:229], v7 offset:53248
    ds_read_b64_tr_b16 v[230:231], v7 offset:54272
    s_waitcnt lgkmcnt(4)
    s_waitcnt vmcnt(0)
    v_cvt_pk_bf16_f32 v184, v184, v185
    v_cvt_pk_bf16_f32 v185, v186, v187
    v_cvt_pk_bf16_f32 v186, v188, v189
    v_cvt_pk_bf16_f32 v187, v190, v191
    s_nop 1
    v_mfma_f32_32x32x16_bf16 v[208:223], v[184:187], v[124:127], v[240:255]
    v_rcp_f32 v56, v200
    s_nop 0
    v_mul_f32 v192, v192, v56
    v_mul_f32 v193, v193, v56
    v_cvt_pk_bf16_f32 v48, v192, v193
    v_mfma_f32_32x32x16_bf16 v[16:31], v[232:235], v[52:55], v[16:31]
    v_mul_f32 v194, v194, v56
    v_mul_f32 v195, v195, v56
    v_cvt_pk_bf16_f32 v49, v194, v195
    v_mul_f32 v196, v196, v56
    v_mul_f32 v197, v197, v56
    v_mfma_f32_32x32x16_bf16 v[32:47], v[236:239], v[52:55], v[32:47]
    v_cvt_pk_bf16_f32 v50, v196, v197
    v_mul_f32 v198, v198, v56
    v_mul_f32 v199, v199, v56
    v_cvt_pk_bf16_f32 v51, v198, v199
    ds_read_b64_tr_b16 v[232:233], v6 offset:55296
    ds_read_b64_tr_b16 v[234:235], v6 offset:56320
    ds_read_b64_tr_b16 v[236:237], v7 offset:55296
    ds_read_b64_tr_b16 v[238:239], v7 offset:56320
    s_waitcnt lgkmcnt(4)
    v_rcp_f32 v56, v216
    s_nop 0
    v_mul_f32 v208, v208, v56
    v_mul_f32 v209, v209, v56
    v_cvt_pk_bf16_f32 v52, v208, v209
    v_mfma_f32_32x32x16_bf16 v[16:31], v[224:227], v[48:51], v[16:31]
    v_mul_f32 v210, v210, v56
    v_mul_f32 v211, v211, v56
    v_cvt_pk_bf16_f32 v53, v210, v211
    v_mul_f32 v212, v212, v56
    v_mul_f32 v213, v213, v56
    v_mfma_f32_32x32x16_bf16 v[32:47], v[228:231], v[48:51], v[32:47]
    v_cvt_pk_bf16_f32 v54, v212, v213
    v_mul_f32 v214, v214, v56
    v_mul_f32 v215, v215, v56
    v_cvt_pk_bf16_f32 v55, v214, v215
    s_waitcnt lgkmcnt(0)
    s_nop 0
    v_mfma_f32_32x32x16_bf16 v[16:31], v[232:235], v[52:55], v[16:31]
    v_mfma_f32_32x32x16_bf16 v[32:47], v[236:239], v[52:55], v[32:47]
    s_lshl_b32 s7, s13, 12
    s_add_u32 s7, s7, 65536
    v_add_u32 v8, s7, v4
    s_xor_b32 s7, s7, 8192
    v_add_u32 v9, s7, v4
    s_lshl_b32 s7, s3, 6
    s_lshl_b32 s10, s5, 5
    s_add_u32 s7, s7, s10
    s_lshl_b32 s7, s7, 11
    s_lshl_b32 s10, s4, 7
    s_add_u32 s7, s7, s10
    s_lshl_b32 s10, s6, 6
    s_add_u32 s7, s7, s10
    v_and_b32 v10, 31, v2
    v_lshlrev_b32 v10, 11, v10
    v_lshrrev_b32 v11, 5, v2
    v_lshl_add_u32 v10, v11, 4, v10
    s_cmp_eq_u32 s6, 0
    s_cbranch_scc1 L_g2_k0
    ds_write_b128 v8, v[16:19] offset:0
    ds_write_b128 v8, v[20:23] offset:1024
    ds_write_b128 v8, v[24:27] offset:2048
    ds_write_b128 v8, v[28:31] offset:3072
    s_waitcnt lgkmcnt(0)
    s_barrier
    ds_read_b128 v[64:67], v9 offset:0
    ds_read_b128 v[68:71], v9 offset:1024
    ds_read_b128 v[72:75], v9 offset:2048
    ds_read_b128 v[76:79], v9 offset:3072
    s_waitcnt lgkmcnt(0)
    v_pk_add_f32 v[32:33], v[32:33], v[64:65]
    v_pk_add_f32 v[34:35], v[34:35], v[66:67]
    v_pk_add_f32 v[36:37], v[36:37], v[68:69]
    v_pk_add_f32 v[38:39], v[38:39], v[70:71]
    v_pk_add_f32 v[40:41], v[40:41], v[72:73]
    v_pk_add_f32 v[42:43], v[42:43], v[74:75]
    v_pk_add_f32 v[44:45], v[44:45], v[76:77]
    v_pk_add_f32 v[46:47], v[46:47], v[78:79]
    v_cvt_pk_bf16_f32 v80, v32, v33
    v_cvt_pk_bf16_f32 v81, v34, v35
    v_cvt_pk_bf16_f32 v82, v36, v37
    v_cvt_pk_bf16_f32 v83, v38, v39
    v_cvt_pk_bf16_f32 v84, v40, v41
    v_cvt_pk_bf16_f32 v85, v42, v43
    v_cvt_pk_bf16_f32 v86, v44, v45
    v_cvt_pk_bf16_f32 v87, v46, v47
    v_permlane32_swap_b32 v80, v82
    v_permlane32_swap_b32 v81, v83
    buffer_store_dwordx4 v[80:83], v10, s[44:47], s7 offen offset:0
    v_permlane32_swap_b32 v84, v86
    v_permlane32_swap_b32 v85, v87
    buffer_store_dwordx4 v[84:87], v10, s[44:47], s7 offen offset:32
    s_endpgm
L_g2_k0:
    ds_write_b128 v8, v[32:35] offset:0
    ds_write_b128 v8, v[36:39] offset:1024
    ds_write_b128 v8, v[40:43] offset:2048
    ds_write_b128 v8, v[44:47] offset:3072
    s_waitcnt lgkmcnt(0)
    s_barrier
    ds_read_b128 v[64:67], v9 offset:0
    ds_read_b128 v[68:71], v9 offset:1024
    ds_read_b128 v[72:75], v9 offset:2048
    ds_read_b128 v[76:79], v9 offset:3072
    s_waitcnt lgkmcnt(0)
    v_pk_add_f32 v[16:17], v[16:17], v[64:65]
    v_pk_add_f32 v[18:19], v[18:19], v[66:67]
    v_pk_add_f32 v[20:21], v[20:21], v[68:69]
    v_pk_add_f32 v[22:23], v[22:23], v[70:71]
    v_pk_add_f32 v[24:25], v[24:25], v[72:73]
    v_pk_add_f32 v[26:27], v[26:27], v[74:75]
    v_pk_add_f32 v[28:29], v[28:29], v[76:77]
    v_pk_add_f32 v[30:31], v[30:31], v[78:79]
    v_cvt_pk_bf16_f32 v80, v16, v17
    v_cvt_pk_bf16_f32 v81, v18, v19
    v_cvt_pk_bf16_f32 v82, v20, v21
    v_cvt_pk_bf16_f32 v83, v22, v23
    v_cvt_pk_bf16_f32 v84, v24, v25
    v_cvt_pk_bf16_f32 v85, v26, v27
    v_cvt_pk_bf16_f32 v86, v28, v29
    v_cvt_pk_bf16_f32 v87, v30, v31
    v_permlane32_swap_b32 v80, v82
    v_permlane32_swap_b32 v81, v83
    buffer_store_dwordx4 v[80:83], v10, s[44:47], s7 offen offset:0
    v_permlane32_swap_b32 v84, v86
    v_permlane32_swap_b32 v85, v87
    buffer_store_dwordx4 v[84:87], v10, s[44:47], s7 offen offset:32
    s_endpgm
L_q0:
    v_mov_b32 v64, s64
    v_mov_b32 v65, s64
    v_mov_b32 v66, s64
    v_mov_b32 v67, s64
    v_mov_b32 v68, s64
    v_mov_b32 v69, s64
    v_mov_b32 v70, s64
    v_mov_b32 v71, s64
    v_mov_b32 v72, s64
    v_mov_b32 v73, s64
    v_mov_b32 v74, s64
    v_mov_b32 v75, s64
    v_mov_b32 v76, s64
    v_mov_b32 v77, s64
    v_mov_b32 v78, s64
    v_mov_b32 v79, s64
    v_mov_b32 v80, s64
    v_mov_b32 v81, s64
    v_mov_b32 v82, s64
    v_mov_b32 v83, s64
    v_mov_b32 v84, s64
    v_mov_b32 v85, s64
    v_mov_b32 v86, s64
    v_mov_b32 v87, s64
    v_mov_b32 v88, s64
    v_mov_b32 v89, s64
    v_mov_b32 v90, s64
    v_mov_b32 v91, s64
    v_mov_b32 v92, s64
    v_mov_b32 v93, s64
    v_mov_b32 v94, s64
    v_mov_b32 v95, s64
    v_mov_b32 v96, s64
    v_mov_b32 v97, s64
    v_mov_b32 v98, s64
    v_mov_b32 v99, s64
    v_mov_b32 v100, s64
    v_mov_b32 v101, s64
    v_mov_b32 v102, s64
    v_mov_b32 v103, s64
    v_mov_b32 v104, s64
    v_mov_b32 v105, s64
    v_mov_b32 v106, s64
    v_mov_b32 v107, s64
    v_mov_b32 v108, s64
    v_mov_b32 v109, s64
    v_mov_b32 v110, s64
    v_mov_b32 v111, s64
    v_mov_b32 v112, s64
    v_mov_b32 v113, s64
    v_mov_b32 v114, s64
    v_mov_b32 v115, s64
    v_mov_b32 v116, s64
    v_mov_b32 v117, s64
    v_mov_b32 v118, s64
    v_mov_b32 v119, s64
    v_mov_b32 v120, s64
    v_mov_b32 v121, s64
    v_mov_b32 v122, s64
    v_mov_b32 v123, s64
    v_mov_b32 v124, s64
    v_mov_b32 v125, s64
    v_mov_b32 v126, s64
    v_mov_b32 v127, s64
    s_waitcnt vmcnt(10)
    s_barrier
    ds_read_b128 v[32:35], v10 offset:0
    ds_read_b64_tr_b16 v[40:41], v14 offset:0
    ds_read_b64_tr_b16 v[42:43], v14 offset:1024
    ds_read_b64_tr_b16 v[44:45], v15 offset:0
    ds_read_b64_tr_b16 v[46:47], v15 offset:1024
    ds_read_b128 v[36:39], v10 offset:4096
    ds_read_b128 v[48:51], v11 offset:0
    ds_read_b64_tr_b16 v[56:57], v14 offset:4096
    ds_read_b64_tr_b16 v[58:59], v14 offset:5120
    ds_read_b64_tr_b16 v[60:61], v15 offset:4096
    ds_read_b64_tr_b16 v[62:63], v15 offset:5120
    ds_read_b128 v[52:55], v11 offset:4096
    s_add_u32 s63, s10, 2
    s_and_b32 s63, s63, 7
    s_lshl_b32 s63, s63, 7
    s_add_u32 m0, s60, 32768
    s_nop 0
    buffer_load_dwordx4 v4, s[44:47], s63 offen offset:0 lds
    s_add_u32 s63, s10, 2
    s_and_b32 s63, s63, 7
    s_lshl_b32 s63, s63, 7
    s_add_u32 m0, s60, 32768
    s_nop 0
    buffer_load_dwordx4 v5, s[44:47], s63 offen offset:1024 lds
    s_add_u32 s63, s10, 2
    s_and_b32 s63, s63, 7
    s_lshl_b32 s63, s63, 7
    s_add_u32 m0, s60, 32768
    s_nop 0
    buffer_load_dwordx4 v6, s[44:47], s63 offen offset:2048 lds
    s_add_u32 s63, s10, 2
    s_and_b32 s63, s63, 7
    s_lshl_b32 s63, s63, 7
    s_add_u32 m0, s60, 32768
    s_nop 0
    buffer_load_dwordx4 v7, s[44:47], s63 offen offset:3072 lds
    s_waitcnt lgkmcnt(6)
    v_mfma_f32_32x32x16_bf16 v[64:79], v[40:43], v[32:35], v[64:79]
    s_waitcnt vmcnt(12) lgkmcnt(0)
    s_barrier
    ds_read_b128 v[224:227], v12 offset:0
    ds_read_b64_tr_b16 v[232:233], v14 offset:8192
    v_mfma_f32_32x32x16_bf16 v[80:95], v[44:47], v[32:35], v[80:95]
    s_add_u32 s63, s62, 4
    s_and_b32 s63, s63, 15
    s_mul_i32 s63, s63, 98304
    s_add_u32 m0, s61, 0
    s_nop 0
    buffer_load_dwordx4 v8, s[48:51], s63 offen offset:0 lds
    ds_read_b64_tr_b16 v[234:235], v14 offset:9216
    ds_read_b64_tr_b16 v[236:237], v15 offset:8192
    v_mfma_f32_32x32x16_bf16 v[96:111], v[40:43], v[36:39], v[96:111]
    ds_read_b64_tr_b16 v[238:239], v15 offset:9216
    ds_read_b128 v[228:231], v12 offset:4096
    v_mfma_f32_32x32x16_bf16 v[112:127], v[44:47], v[36:39], v[112:127]
    s_add_u32 s63, s62, 4
    s_and_b32 s63, s63, 15
    s_mul_i32 s63, s63, 98304
    s_add_u32 m0, s61, 0
    s_nop 0
    buffer_load_dwordx4 v9, s[48:51], s63 offen offset:1024 lds
    v_mfma_f32_32x32x16_bf16 v[64:79], v[56:59], v[48:51], v[64:79]
    ds_read_b128 v[32:35], v13 offset:0
    ds_read_b64_tr_b16 v[40:41], v14 offset:12288
    v_mfma_f32_32x32x16_bf16 v[80:95], v[60:63], v[48:51], v[80:95]
    ds_read_b64_tr_b16 v[42:43], v14 offset:13312
    ds_read_b64_tr_b16 v[44:45], v15 offset:12288
    v_mfma_f32_32x32x16_bf16 v[96:111], v[56:59], v[52:55], v[96:111]
    ds_read_b64_tr_b16 v[46:47], v15 offset:13312
    ds_read_b128 v[36:39], v13 offset:4096
    v_mfma_f32_32x32x16_bf16 v[112:127], v[60:63], v[52:55], v[112:127]
    s_waitcnt lgkmcnt(6)
    v_mfma_f32_32x32x16_bf16 v[64:79], v[232:235], v[224:227], v[64:79]
    s_waitcnt vmcnt(8) lgkmcnt(0)
    s_barrier
    ds_read_b128 v[48:51], v10 offset:16384
    ds_read_b64_tr_b16 v[56:57], v14 offset:16384
    v_mfma_f32_32x32x16_bf16 v[80:95], v[236:239], v[224:227], v[80:95]
    s_add_u32 s63, s62, 5
    s_and_b32 s63, s63, 15
    s_mul_i32 s63, s63, 98304
    s_add_u32 m0, s61, 8192
    s_nop 0
    buffer_load_dwordx4 v8, s[48:51], s63 offen offset:0 lds
    ds_read_b64_tr_b16 v[58:59], v14 offset:17408
    ds_read_b64_tr_b16 v[60:61], v15 offset:16384
    v_mfma_f32_32x32x16_bf16 v[96:111], v[232:235], v[228:231], v[96:111]
    ds_read_b64_tr_b16 v[62:63], v15 offset:17408
    ds_read_b128 v[52:55], v10 offset:20480
    v_mfma_f32_32x32x16_bf16 v[112:127], v[236:239], v[228:231], v[112:127]
    s_add_u32 s63, s62, 5
    s_and_b32 s63, s63, 15
    s_mul_i32 s63, s63, 98304
    s_add_u32 m0, s61, 8192
    s_nop 0
    buffer_load_dwordx4 v9, s[48:51], s63 offen offset:1024 lds
    v_mfma_f32_32x32x16_bf16 v[64:79], v[40:43], v[32:35], v[64:79]
    ds_read_b128 v[224:227], v11 offset:16384
    ds_read_b64_tr_b16 v[232:233], v14 offset:20480
    v_mfma_f32_32x32x16_bf16 v[80:95], v[44:47], v[32:35], v[80:95]
    s_add_u32 s63, s10, 3
    s_and_b32 s63, s63, 7
    s_lshl_b32 s63, s63, 7
    s_add_u32 m0, s60, 0
    s_nop 0
    buffer_load_dwordx4 v4, s[44:47], s63 offen offset:0 lds
    ds_read_b64_tr_b16 v[234:235], v14 offset:21504
    ds_read_b64_tr_b16 v[236:237], v15 offset:20480
    v_mfma_f32_32x32x16_bf16 v[96:111], v[40:43], v[36:39], v[96:111]
    ds_read_b64_tr_b16 v[238:239], v15 offset:21504
    ds_read_b128 v[228:231], v11 offset:20480
    v_mfma_f32_32x32x16_bf16 v[112:127], v[44:47], v[36:39], v[112:127]
    s_add_u32 s63, s10, 3
    s_and_b32 s63, s63, 7
    s_lshl_b32 s63, s63, 7
    s_add_u32 m0, s60, 0
    s_nop 0
    buffer_load_dwordx4 v5, s[44:47], s63 offen offset:1024 lds
    s_waitcnt lgkmcnt(6)
    v_mfma_f32_32x32x16_bf16 v[64:79], v[56:59], v[48:51], v[64:79]
    s_waitcnt vmcnt(10) lgkmcnt(0)
    s_barrier
    ds_read_b128 v[32:35], v12 offset:16384
    ds_read_b64_tr_b16 v[40:41], v14 offset:24576
    v_mfma_f32_32x32x16_bf16 v[80:95], v[60:63], v[48:51], v[80:95]
    s_add_u32 s63, s10, 3
    s_and_b32 s63, s63, 7
    s_lshl_b32 s63, s63, 7
    s_add_u32 m0, s60, 0
    s_nop 0
    buffer_load_dwordx4 v6, s[44:47], s63 offen offset:2048 lds
    ds_read_b64_tr_b16 v[42:43], v14 offset:25600
    ds_read_b64_tr_b16 v[44:45], v15 offset:24576
    v_mfma_f32_32x32x16_bf16 v[96:111], v[56:59], v[52:55], v[96:111]
    ds_read_b64_tr_b16 v[46:47], v15 offset:25600
    ds_read_b128 v[36:39], v12 offset:20480
    v_mfma_f32_32x32x16_bf16 v[112:127], v[60:63], v[52:55], v[112:127]
    s_add_u32 s63, s10, 3
    s_and_b32 s63, s63, 7
    s_lshl_b32 s63, s63, 7
    s_add_u32 m0, s60, 0
    s_nop 0
    buffer_load_dwordx4 v7, s[44:47], s63 offen offset:3072 lds
    v_mfma_f32_32x32x16_bf16 v[64:79], v[232:235], v[224:227], v[64:79]
    ds_read_b128 v[48:51], v13 offset:16384
    ds_read_b64_tr_b16 v[56:57], v14 offset:28672
    v_mfma_f32_32x32x16_bf16 v[80:95], v[236:239], v[224:227], v[80:95]
    s_add_u32 s63, s62, 6
    s_and_b32 s63, s63, 15
    s_mul_i32 s63, s63, 98304
    s_add_u32 m0, s61, 16384
    s_nop 0
    buffer_load_dwordx4 v8, s[48:51], s63 offen offset:0 lds
    ds_read_b64_tr_b16 v[58:59], v14 offset:29696
    ds_read_b64_tr_b16 v[60:61], v15 offset:28672
    v_mfma_f32_32x32x16_bf16 v[96:111], v[232:235], v[228:231], v[96:111]
    ds_read_b64_tr_b16 v[62:63], v15 offset:29696
    ds_read_b128 v[52:55], v13 offset:20480
    v_mfma_f32_32x32x16_bf16 v[112:127], v[236:239], v[228:231], v[112:127]
    s_add_u32 s63, s62, 6
    s_and_b32 s63, s63, 15
    s_mul_i32 s63, s63, 98304
    s_add_u32 m0, s61, 16384
    s_nop 0
    buffer_load_dwordx4 v9, s[48:51], s63 offen offset:1024 lds
    s_waitcnt lgkmcnt(6)
    v_mfma_f32_32x32x16_bf16 v[64:79], v[40:43], v[32:35], v[64:79]
    s_waitcnt vmcnt(8) lgkmcnt(0)
    s_barrier
    ds_read_b128 v[224:227], v10 offset:32768
    ds_read_b64_tr_b16 v[232:233], v14 offset:0
    v_mfma_f32_32x32x16_bf16 v[80:95], v[44:47], v[32:35], v[80:95]
    s_add_u32 s63, s62, 7
    s_and_b32 s63, s63, 15
    s_mul_i32 s63, s63, 98304
    s_add_u32 m0, s61, 24576
    s_nop 0
    buffer_load_dwordx4 v8, s[48:51], s63 offen offset:0 lds
    ds_read_b64_tr_b16 v[234:235], v14 offset:1024
    ds_read_b64_tr_b16 v[236:237], v15 offset:0
    v_mfma_f32_32x32x16_bf16 v[96:111], v[40:43], v[36:39], v[96:111]
    ds_read_b64_tr_b16 v[238:239], v15 offset:1024
    ds_read_b128 v[228:231], v10 offset:36864
    v_mfma_f32_32x32x16_bf16 v[112:127], v[44:47], v[36:39], v[112:127]
    s_add_u32 s63, s62, 7
    s_and_b32 s63, s63, 15
    s_mul_i32 s63, s63, 98304
    s_add_u32 m0, s61, 24576
    s_nop 0
    buffer_load_dwordx4 v9, s[48:51], s63 offen offset:1024 lds
    v_mfma_f32_32x32x16_bf16 v[64:79], v[56:59], v[48:51], v[64:79]
    ds_read_b128 v[32:35], v11 offset:32768
    ds_read_b64_tr_b16 v[40:41], v14 offset:4096
    v_mfma_f32_32x32x16_bf16 v[80:95], v[60:63], v[48:51], v[80:95]
    s_add_u32 s63, s10, 4
    s_and_b32 s63, s63, 7
    s_lshl_b32 s63, s63, 7
    s_add_u32 m0, s60, 16384
    s_nop 0
    buffer_load_dwordx4 v4, s[44:47], s63 offen offset:0 lds
    ds_read_b64_tr_b16 v[42:43], v14 offset:5120
    ds_read_b64_tr_b16 v[44:45], v15 offset:4096
    v_mfma_f32_32x32x16_bf16 v[96:111], v[56:59], v[52:55], v[96:111]
    ds_read_b64_tr_b16 v[46:47], v15 offset:5120
    ds_read_b128 v[36:39], v11 offset:36864
    v_mfma_f32_32x32x16_bf16 v[112:127], v[60:63], v[52:55], v[112:127]
    s_add_u32 s63, s10, 4
    s_and_b32 s63, s63, 7
    s_lshl_b32 s63, s63, 7
    s_add_u32 m0, s60, 16384
    s_nop 0
    buffer_load_dwordx4 v5, s[44:47], s63 offen offset:1024 lds
    s_waitcnt lgkmcnt(6)
    v_mfma_f32_32x32x16_bf16 v[64:79], v[232:235], v[224:227], v[64:79]
    s_waitcnt vmcnt(10) lgkmcnt(0)
    s_barrier
    ds_read_b128 v[48:51], v12 offset:32768
    ds_read_b64_tr_b16 v[56:57], v14 offset:8192
    v_mfma_f32_32x32x16_bf16 v[80:95], v[236:239], v[224:227], v[80:95]
    s_add_u32 s63, s10, 4
    s_and_b32 s63, s63, 7
    s_lshl_b32 s63, s63, 7
    s_add_u32 m0, s60, 16384
    s_nop 0
    buffer_load_dwordx4 v6, s[44:47], s63 offen offset:2048 lds
    ds_read_b64_tr_b16 v[58:59], v14 offset:9216
    ds_read_b64_tr_b16 v[60:61], v15 offset:8192
    v_mfma_f32_32x32x16_bf16 v[96:111], v[232:235], v[228:231], v[96:111]
    ds_read_b64_tr_b16 v[62:63], v15 offset:9216
    ds_read_b128 v[52:55], v12 offset:36864
    v_mfma_f32_32x32x16_bf16 v[112:127], v[236:239], v[228:231], v[112:127]
    s_add_u32 s63, s10, 4
    s_and_b32 s63, s63, 7
    s_lshl_b32 s63, s63, 7
    s_add_u32 m0, s60, 16384
    s_nop 0
    buffer_load_dwordx4 v7, s[44:47], s63 offen offset:3072 lds
    v_mfma_f32_32x32x16_bf16 v[64:79], v[40:43], v[32:35], v[64:79]
    ds_read_b128 v[224:227], v13 offset:32768
    ds_read_b64_tr_b16 v[232:233], v14 offset:12288
    v_mfma_f32_32x32x16_bf16 v[80:95], v[44:47], v[32:35], v[80:95]
    s_add_u32 s63, s62, 8
    s_and_b32 s63, s63, 15
    s_mul_i32 s63, s63, 98304
    s_add_u32 m0, s61, 0
    s_nop 0
    buffer_load_dwordx4 v8, s[48:51], s63 offen offset:0 lds
    ds_read_b64_tr_b16 v[234:235], v14 offset:13312
    ds_read_b64_tr_b16 v[236:237], v15 offset:12288
    v_mfma_f32_32x32x16_bf16 v[96:111], v[40:43], v[36:39], v[96:111]
    ds_read_b64_tr_b16 v[238:239], v15 offset:13312
    ds_read_b128 v[228:231], v13 offset:36864
    v_mfma_f32_32x32x16_bf16 v[112:127], v[44:47], v[36:39], v[112:127]
    s_add_u32 s63, s62, 8
    s_and_b32 s63, s63, 15
    s_mul_i32 s63, s63, 98304
    s_add_u32 m0, s61, 0
    s_nop 0
    buffer_load_dwordx4 v9, s[48:51], s63 offen offset:1024 lds
    s_waitcnt lgkmcnt(6)
    v_mfma_f32_32x32x16_bf16 v[64:79], v[56:59], v[48:51], v[64:79]
    s_waitcnt vmcnt(8) lgkmcnt(0)
    s_barrier
    ds_read_b128 v[32:35], v10 offset:0
    ds_read_b64_tr_b16 v[40:41], v14 offset:16384
    v_mfma_f32_32x32x16_bf16 v[80:95], v[60:63], v[48:51], v[80:95]
    s_add_u32 s63, s62, 9
    s_and_b32 s63, s63, 15
    s_mul_i32 s63, s63, 98304
    s_add_u32 m0, s61, 8192
    s_nop 0
    buffer_load_dwordx4 v8, s[48:51], s63 offen offset:0 lds
    ds_read_b64_tr_b16 v[42:43], v14 offset:17408
    ds_read_b64_tr_b16 v[44:45], v15 offset:16384
    v_mfma_f32_32x32x16_bf16 v[96:111], v[56:59], v[52:55], v[96:111]
    ds_read_b64_tr_b16 v[46:47], v15 offset:17408
    ds_read_b128 v[36:39], v10 offset:4096
    v_mfma_f32_32x32x16_bf16 v[112:127], v[60:63], v[52:55], v[112:127]
    s_add_u32 s63, s62, 9
    s_and_b32 s63, s63, 15
    s_mul_i32 s63, s63, 98304
    s_add_u32 m0, s61, 8192
    s_nop 0
    buffer_load_dwordx4 v9, s[48:51], s63 offen offset:1024 lds
    v_mfma_f32_32x32x16_bf16 v[64:79], v[232:235], v[224:227], v[64:79]
    ds_read_b128 v[48:51], v11 offset:0
    ds_read_b64_tr_b16 v[56:57], v14 offset:20480
    v_mfma_f32_32x32x16_bf16 v[80:95], v[236:239], v[224:227], v[80:95]
    s_add_u32 s63, s10, 5
    s_and_b32 s63, s63, 7
    s_lshl_b32 s63, s63, 7
    s_add_u32 m0, s60, 32768
    s_nop 0
    buffer_load_dwordx4 v4, s[44:47], s63 offen offset:0 lds
    ds_read_b64_tr_b16 v[58:59], v14 offset:21504
    ds_read_b64_tr_b16 v[60:61], v15 offset:20480
    v_mfma_f32_32x32x16_bf16 v[96:111], v[232:235], v[228:231], v[96:111]
    ds_read_b64_tr_b16 v[62:63], v15 offset:21504
    ds_read_b128 v[52:55], v11 offset:4096
    v_mfma_f32_32x32x16_bf16 v[112:127], v[236:239], v[228:231], v[112:127]
    s_add_u32 s63, s10, 5
    s_and_b32 s63, s63, 7
    s_lshl_b32 s63, s63, 7
    s_add_u32 m0, s60, 32768
    s_nop 0
    buffer_load_dwordx4 v5, s[44:47], s63 offen offset:1024 lds
    s_waitcnt lgkmcnt(6)
    v_mfma_f32_32x32x16_bf16 v[64:79], v[40:43], v[32:35], v[64:79]
    s_waitcnt vmcnt(10) lgkmcnt(0)
    s_barrier
    ds_read_b128 v[224:227], v12 offset:0
    ds_read_b64_tr_b16 v[232:233], v14 offset:24576
    v_mfma_f32_32x32x16_bf16 v[80:95], v[44:47], v[32:35], v[80:95]
    s_add_u32 s63, s10, 5
    s_and_b32 s63, s63, 7
    s_lshl_b32 s63, s63, 7
    s_add_u32 m0, s60, 32768
    s_nop 0
    buffer_load_dwordx4 v6, s[44:47], s63 offen offset:2048 lds
    ds_read_b64_tr_b16 v[234:235], v14 offset:25600
    ds_read_b64_tr_b16 v[236:237], v15 offset:24576
    v_mfma_f32_32x32x16_bf16 v[96:111], v[40:43], v[36:39], v[96:111]
    ds_read_b64_tr_b16 v[238:239], v15 offset:25600
    ds_read_b128 v[228:231], v12 offset:4096
    v_mfma_f32_32x32x16_bf16 v[112:127], v[44:47], v[36:39], v[112:127]
    s_add_u32 s63, s10, 5
    s_and_b32 s63, s63, 7
    s_lshl_b32 s63, s63, 7
    s_add_u32 m0, s60, 32768
    s_nop 0
    buffer_load_dwordx4 v7, s[44:47], s63 offen offset:3072 lds
    v_mfma_f32_32x32x16_bf16 v[64:79], v[56:59], v[48:51], v[64:79]
    ds_read_b128 v[32:35], v13 offset:0
    ds_read_b64_tr_b16 v[40:41], v14 offset:28672
    v_mfma_f32_32x32x16_bf16 v[80:95], v[60:63], v[48:51], v[80:95]
    s_add_u32 s63, s62, 10
    s_and_b32 s63, s63, 15
    s_mul_i32 s63, s63, 98304
    s_add_u32 m0, s61, 16384
    s_nop 0
    buffer_load_dwordx4 v8, s[48:51], s63 offen offset:0 lds
    ds_read_b64_tr_b16 v[42:43], v14 offset:29696
    ds_read_b64_tr_b16 v[44:45], v15 offset:28672
    v_mfma_f32_32x32x16_bf16 v[96:111], v[56:59], v[52:55], v[96:111]
    ds_read_b64_tr_b16 v[46:47], v15 offset:29696
    ds_read_b128 v[36:39], v13 offset:4096
    v_mfma_f32_32x32x16_bf16 v[112:127], v[60:63], v[52:55], v[112:127]
    s_add_u32 s63, s62, 10
    s_and_b32 s63, s63, 15
    s_mul_i32 s63, s63, 98304
    s_add_u32 m0, s61, 16384
    s_nop 0
    buffer_load_dwordx4 v9, s[48:51], s63 offen offset:1024 lds
    s_waitcnt lgkmcnt(6)
    v_mfma_f32_32x32x16_bf16 v[64:79], v[232:235], v[224:227], v[64:79]
    s_waitcnt vmcnt(8) lgkmcnt(0)
    s_barrier
    ds_read_b128 v[48:51], v10 offset:16384
    ds_read_b64_tr_b16 v[56:57], v14 offset:0
    v_mfma_f32_32x32x16_bf16 v[80:95], v[236:239], v[224:227], v[80:95]
    s_add_u32 s63, s62, 11
    s_and_b32 s63, s63, 15
    s_mul_i32 s63, s63, 98304
    s_add_u32 m0, s61, 24576
    s_nop 0
    buffer_load_dwordx4 v8, s[48:51], s63 offen offset:0 lds
    ds_read_b64_tr_b16 v[58:59], v14 offset:1024
    ds_read_b64_tr_b16 v[60:61], v15 offset:0
    v_mfma_f32_32x32x16_bf16 v[96:111], v[232:235], v[228:231], v[96:111]
    ds_read_b64_tr_b16 v[62:63], v15 offset:1024
    ds_read_b128 v[52:55], v10 offset:20480
    v_mfma_f32_32x32x16_bf16 v[112:127], v[236:239], v[228:231], v[112:127]
    s_add_u32 s63, s62, 11
    s_and_b32 s63, s63, 15
    s_mul_i32 s63, s63, 98304
    s_add_u32 m0, s61, 24576
    s_nop 0
    buffer_load_dwordx4 v9, s[48:51], s63 offen offset:1024 lds
    v_mfma_f32_32x32x16_bf16 v[64:79], v[40:43], v[32:35], v[64:79]
    ds_read_b128 v[224:227], v11 offset:16384
    ds_read_b64_tr_b16 v[232:233], v14 offset:4096
    v_mfma_f32_32x32x16_bf16 v[80:95], v[44:47], v[32:35], v[80:95]
    s_add_u32 s63, s10, 6
    s_and_b32 s63, s63, 7
    s_lshl_b32 s63, s63, 7
    s_add_u32 m0, s60, 0
    s_nop 0
    buffer_load_dwordx4 v4, s[44:47], s63 offen offset:0 lds
    ds_read_b64_tr_b16 v[234:235], v14 offset:5120
    ds_read_b64_tr_b16 v[236:237], v15 offset:4096
    v_mfma_f32_32x32x16_bf16 v[96:111], v[40:43], v[36:39], v[96:111]
    ds_read_b64_tr_b16 v[238:239], v15 offset:5120
    ds_read_b128 v[228:231], v11 offset:20480
    v_mfma_f32_32x32x16_bf16 v[112:127], v[44:47], v[36:39], v[112:127]
    s_add_u32 s63, s10, 6
    s_and_b32 s63, s63, 7
    s_lshl_b32 s63, s63, 7
    s_add_u32 m0, s60, 0
    s_nop 0
    buffer_load_dwordx4 v5, s[44:47], s63 offen offset:1024 lds
    s_waitcnt lgkmcnt(6)
    v_mfma_f32_32x32x16_bf16 v[64:79], v[56:59], v[48:51], v[64:79]
    s_waitcnt vmcnt(10) lgkmcnt(0)
    s_barrier
    ds_read_b128 v[32:35], v12 offset:16384
    ds_read_b64_tr_b16 v[40:41], v14 offset:8192
    v_mfma_f32_32x32x16_bf16 v[80:95], v[60:63], v[48:51], v[80:95]
    s_add_u32 s63, s10, 6
    s_and_b32 s63, s63, 7
    s_lshl_b32 s63, s63, 7
    s_add_u32 m0, s60, 0
    s_nop 0
    buffer_load_dwordx4 v6, s[44:47], s63 offen offset:2048 lds
    ds_read_b64_tr_b16 v[42:43], v14 offset:9216
    ds_read_b64_tr_b16 v[44:45], v15 offset:8192
    v_mfma_f32_32x32x16_bf16 v[96:111], v[56:59], v[52:55], v[96:111]
    ds_read_b64_tr_b16 v[46:47], v15 offset:9216
    ds_read_b128 v[36:39], v12 offset:20480
    v_mfma_f32_32x32x16_bf16 v[112:127], v[60:63], v[52:55], v[112:127]
    s_add_u32 s63, s10, 6
    s_and_b32 s63, s63, 7
    s_lshl_b32 s63, s63, 7
    s_add_u32 m0, s60, 0
    s_nop 0
    buffer_load_dwordx4 v7, s[44:47], s63 offen offset:3072 lds
    v_mfma_f32_32x32x16_bf16 v[64:79], v[232:235], v[224:227], v[64:79]
    ds_read_b128 v[48:51], v13 offset:16384
    ds_read_b64_tr_b16 v[56:57], v14 offset:12288
    v_mfma_f32_32x32x16_bf16 v[80:95], v[236:239], v[224:227], v[80:95]
    s_add_u32 s63, s62, 12
    s_and_b32 s63, s63, 15
    s_mul_i32 s63, s63, 98304
    s_add_u32 m0, s61, 0
    s_nop 0
    buffer_load_dwordx4 v8, s[48:51], s63 offen offset:0 lds
    ds_read_b64_tr_b16 v[58:59], v14 offset:13312
    ds_read_b64_tr_b16 v[60:61], v15 offset:12288
    v_mfma_f32_32x32x16_bf16 v[96:111], v[232:235], v[228:231], v[96:111]
    ds_read_b64_tr_b16 v[62:63], v15 offset:13312
    ds_read_b128 v[52:55], v13 offset:20480
    v_mfma_f32_32x32x16_bf16 v[112:127], v[236:239], v[228:231], v[112:127]
    s_add_u32 s63, s62, 12
    s_and_b32 s63, s63, 15
    s_mul_i32 s63, s63, 98304
    s_add_u32 m0, s61, 0
    s_nop 0
    buffer_load_dwordx4 v9, s[48:51], s63 offen offset:1024 lds
    s_waitcnt lgkmcnt(6)
    v_mfma_f32_32x32x16_bf16 v[64:79], v[40:43], v[32:35], v[64:79]
    s_waitcnt vmcnt(8) lgkmcnt(0)
    s_barrier
    ds_read_b128 v[224:227], v10 offset:32768
    ds_read_b64_tr_b16 v[232:233], v14 offset:16384
    v_mfma_f32_32x32x16_bf16 v[80:95], v[44:47], v[32:35], v[80:95]
    s_add_u32 s63, s62, 13
    s_and_b32 s63, s63, 15
    s_mul_i32 s63, s63, 98304
    s_add_u32 m0, s61, 8192
    s_nop 0
    buffer_load_dwordx4 v8, s[48:51], s63 offen offset:0 lds
    ds_read_b64_tr_b16 v[234:235], v14 offset:17408
    ds_read_b64_tr_b16 v[236:237], v15 offset:16384
    v_mfma_f32_32x32x16_bf16 v[96:111], v[40:43], v[36:39], v[96:111]
    ds_read_b64_tr_b16 v[238:239], v15 offset:17408
    ds_read_b128 v[228:231], v10 offset:36864
    v_mfma_f32_32x32x16_bf16 v[112:127], v[44:47], v[36:39], v[112:127]
    s_add_u32 s63, s62, 13
    s_and_b32 s63, s63, 15
    s_mul_i32 s63, s63, 98304
    s_add_u32 m0, s61, 8192
    s_nop 0
    buffer_load_dwordx4 v9, s[48:51], s63 offen offset:1024 lds
    v_mfma_f32_32x32x16_bf16 v[64:79], v[56:59], v[48:51], v[64:79]
    ds_read_b128 v[32:35], v11 offset:32768
    ds_read_b64_tr_b16 v[40:41], v14 offset:20480
    v_mfma_f32_32x32x16_bf16 v[80:95], v[60:63], v[48:51], v[80:95]
    s_add_u32 s63, s10, 7
    s_and_b32 s63, s63, 7
    s_lshl_b32 s63, s63, 7
    s_add_u32 m0, s60, 16384
    s_nop 0
    buffer_load_dwordx4 v4, s[44:47], s63 offen offset:0 lds
    ds_read_b64_tr_b16 v[42:43], v14 offset:21504
    ds_read_b64_tr_b16 v[44:45], v15 offset:20480
    v_mfma_f32_32x32x16_bf16 v[96:111], v[56:59], v[52:55], v[96:111]
    ds_read_b64_tr_b16 v[46:47], v15 offset:21504
    ds_read_b128 v[36:39], v11 offset:36864
    v_mfma_f32_32x32x16_bf16 v[112:127], v[60:63], v[52:55], v[112:127]
    s_add_u32 s63, s10, 7
    s_and_b32 s63, s63, 7
    s_lshl_b32 s63, s63, 7
    s_add_u32 m0, s60, 16384
    s_nop 0
    buffer_load_dwordx4 v5, s[44:47], s63 offen offset:1024 lds
    s_waitcnt lgkmcnt(6)
    v_mfma_f32_32x32x16_bf16 v[64:79], v[232:235], v[224:227], v[64:79]
    s_waitcnt vmcnt(10) lgkmcnt(0)
    s_barrier
    ds_read_b128 v[48:51], v12 offset:32768
    ds_read_b64_tr_b16 v[56:57], v14 offset:24576
    v_mfma_f32_32x32x16_bf16 v[80:95], v[236:239], v[224:227], v[80:95]
    s_add_u32 s63, s10, 7
    s_and_b32 s63, s63, 7
    s_lshl_b32 s63, s63, 7
    s_add_u32 m0, s60, 16384
    s_nop 0
    buffer_load_dwordx4 v6, s[44:47], s63 offen offset:2048 lds
    ds_read_b64_tr_b16 v[58:59], v14 offset:25600
    ds_read_b64_tr_b16 v[60:61], v15 offset:24576
    v_mfma_f32_32x32x16_bf16 v[96:111], v[232:235], v[228:231], v[96:111]
    ds_read_b64_tr_b16 v[62:63], v15 offset:25600
    ds_read_b128 v[52:55], v12 offset:36864
    v_mfma_f32_32x32x16_bf16 v[112:127], v[236:239], v[228:231], v[112:127]
    s_add_u32 s63, s10, 7
    s_and_b32 s63, s63, 7
    s_lshl_b32 s63, s63, 7
    s_add_u32 m0, s60, 16384
    s_nop 0
    buffer_load_dwordx4 v7, s[44:47], s63 offen offset:3072 lds
    v_mfma_f32_32x32x16_bf16 v[64:79], v[40:43], v[32:35], v[64:79]
    ds_read_b128 v[224:227], v13 offset:32768
    ds_read_b64_tr_b16 v[232:233], v14 offset:28672
    v_mfma_f32_32x32x16_bf16 v[80:95], v[44:47], v[32:35], v[80:95]
    s_add_u32 s63, s62, 14
    s_and_b32 s63, s63, 15
    s_mul_i32 s63, s63, 98304
    s_add_u32 m0, s61, 16384
    s_nop 0
    buffer_load_dwordx4 v8, s[48:51], s63 offen offset:0 lds
    ds_read_b64_tr_b16 v[234:235], v14 offset:29696
    ds_read_b64_tr_b16 v[236:237], v15 offset:28672
    v_mfma_f32_32x32x16_bf16 v[96:111], v[40:43], v[36:39], v[96:111]
    ds_read_b64_tr_b16 v[238:239], v15 offset:29696
    ds_read_b128 v[228:231], v13 offset:36864
    v_mfma_f32_32x32x16_bf16 v[112:127], v[44:47], v[36:39], v[112:127]
    s_add_u32 s63, s62, 14
    s_and_b32 s63, s63, 15
    s_mul_i32 s63, s63, 98304
    s_add_u32 m0, s61, 16384
    s_nop 0
    buffer_load_dwordx4 v9, s[48:51], s63 offen offset:1024 lds
    s_waitcnt lgkmcnt(6)
    v_mfma_f32_32x32x16_bf16 v[64:79], v[56:59], v[48:51], v[64:79]
    s_waitcnt vmcnt(8) lgkmcnt(0)
    s_barrier
    ds_read_b128 v[32:35], v10 offset:0
    ds_read_b64_tr_b16 v[40:41], v14 offset:0
    v_mfma_f32_32x32x16_bf16 v[80:95], v[60:63], v[48:51], v[80:95]
    s_add_u32 s63, s62, 15
    s_and_b32 s63, s63, 15
    s_mul_i32 s63, s63, 98304
    s_add_u32 m0, s61, 24576
    s_nop 0
    buffer_load_dwordx4 v8, s[48:51], s63 offen offset:0 lds
    ds_read_b64_tr_b16 v[42:43], v14 offset:1024
    ds_read_b64_tr_b16 v[44:45], v15 offset:0
    v_mfma_f32_32x32x16_bf16 v[96:111], v[56:59], v[52:55], v[96:111]
    ds_read_b64_tr_b16 v[46:47], v15 offset:1024
    ds_read_b128 v[36:39], v10 offset:4096
    v_mfma_f32_32x32x16_bf16 v[112:127], v[60:63], v[52:55], v[112:127]
    s_add_u32 s63, s62, 15
    s_and_b32 s63, s63, 15
    s_mul_i32 s63, s63, 98304
    s_add_u32 m0, s61, 24576
    s_nop 0
    buffer_load_dwordx4 v9, s[48:51], s63 offen offset:1024 lds
    buffer_load_dwordx2 v[244:245], v21, s[56:59], 0 offen sc1
    v_mfma_f32_32x32x16_bf16 v[64:79], v[232:235], v[224:227], v[64:79]
    ds_read_b128 v[48:51], v11 offset:0
    ds_read_b64_tr_b16 v[56:57], v14 offset:4096
    v_mfma_f32_32x32x16_bf16 v[80:95], v[236:239], v[224:227], v[80:95]
    ds_read_b64_tr_b16 v[58:59], v14 offset:5120
    ds_read_b64_tr_b16 v[60:61], v15 offset:4096
    v_mfma_f32_32x32x16_bf16 v[96:111], v[232:235], v[228:231], v[96:111]
    ds_read_b64_tr_b16 v[62:63], v15 offset:5120
    ds_read_b128 v[52:55], v11 offset:4096
    v_mfma_f32_32x32x16_bf16 v[112:127], v[236:239], v[228:231], v[112:127]
    s_waitcnt lgkmcnt(6)
    v_mfma_f32_32x32x16_bf16 v[64:79], v[40:43], v[32:35], v[64:79]
    s_waitcnt vmcnt(9) lgkmcnt(0)
    s_barrier
    ds_read_b128 v[224:227], v12 offset:0
    ds_read_b64_tr_b16 v[232:233], v14 offset:8192
    v_mfma_f32_32x32x16_bf16 v[80:95], v[44:47], v[32:35], v[80:95]
    ds_read_b64_tr_b16 v[234:235], v14 offset:9216
    ds_read_b64_tr_b16 v[236:237], v15 offset:8192
    v_mfma_f32_32x32x16_bf16 v[96:111], v[40:43], v[36:39], v[96:111]
    ds_read_b64_tr_b16 v[238:239], v15 offset:9216
    ds_read_b128 v[228:231], v12 offset:4096
    v_mfma_f32_32x32x16_bf16 v[112:127], v[44:47], v[36:39], v[112:127]
    v_mfma_f32_32x32x16_bf16 v[64:79], v[56:59], v[48:51], v[64:79]
    ds_read_b128 v[32:35], v13 offset:0
    ds_read_b64_tr_b16 v[40:41], v14 offset:12288
    v_mfma_f32_32x32x16_bf16 v[80:95], v[60:63], v[48:51], v[80:95]
    ds_read_b64_tr_b16 v[42:43], v14 offset:13312
    ds_read_b64_tr_b16 v[44:45], v15 offset:12288
    v_mfma_f32_32x32x16_bf16 v[96:111], v[56:59], v[52:55], v[96:111]
    ds_read_b64_tr_b16 v[46:47], v15 offset:13312
    ds_read_b128 v[36:39], v13 offset:4096
    v_mfma_f32_32x32x16_bf16 v[112:127], v[60:63], v[52:55], v[112:127]
    s_waitcnt lgkmcnt(6)
    v_mfma_f32_32x32x16_bf16 v[64:79], v[232:235], v[224:227], v[64:79]
    s_waitcnt vmcnt(3) lgkmcnt(0)
    s_barrier
    ds_read_b128 v[48:51], v10 offset:16384
    ds_read_b64_tr_b16 v[56:57], v14 offset:16384
    v_mfma_f32_32x32x16_bf16 v[80:95], v[236:239], v[224:227], v[80:95]
    ds_read_b64_tr_b16 v[58:59], v14 offset:17408
    ds_read_b64_tr_b16 v[60:61], v15 offset:16384
    v_mfma_f32_32x32x16_bf16 v[96:111], v[232:235], v[228:231], v[96:111]
    ds_read_b64_tr_b16 v[62:63], v15 offset:17408
    ds_read_b128 v[52:55], v10 offset:20480
    v_mfma_f32_32x32x16_bf16 v[112:127], v[236:239], v[228:231], v[112:127]
    v_mfma_f32_32x32x16_bf16 v[64:79], v[40:43], v[32:35], v[64:79]
    ds_read_b128 v[224:227], v11 offset:16384
    ds_read_b64_tr_b16 v[232:233], v14 offset:20480
    v_mfma_f32_32x32x16_bf16 v[80:95], v[44:47], v[32:35], v[80:95]
    ds_read_b64_tr_b16 v[234:235], v14 offset:21504
    ds_read_b64_tr_b16 v[236:237], v15 offset:20480
    v_mfma_f32_32x32x16_bf16 v[96:111], v[40:43], v[36:39], v[96:111]
    ds_read_b64_tr_b16 v[238:239], v15 offset:21504
    ds_read_b128 v[228:231], v11 offset:20480
    v_mfma_f32_32x32x16_bf16 v[112:127], v[44:47], v[36:39], v[112:127]
    s_waitcnt lgkmcnt(6)
    v_mfma_f32_32x32x16_bf16 v[64:79], v[56:59], v[48:51], v[64:79]
    s_waitcnt vmcnt(1) lgkmcnt(0)
    s_barrier
    ds_read_b128 v[32:35], v12 offset:16384
    ds_read_b64_tr_b16 v[40:41], v14 offset:24576
    v_mfma_f32_32x32x16_bf16 v[80:95], v[60:63], v[48:51], v[80:95]
    ds_read_b64_tr_b16 v[42:43], v14 offset:25600
    ds_read_b64_tr_b16 v[44:45], v15 offset:24576
    v_mfma_f32_32x32x16_bf16 v[96:111], v[56:59], v[52:55], v[96:111]
    ds_read_b64_tr_b16 v[46:47], v15 offset:25600
    ds_read_b128 v[36:39], v12 offset:20480
    v_mfma_f32_32x32x16_bf16 v[112:127], v[60:63], v[52:55], v[112:127]
    v_mfma_f32_32x32x16_bf16 v[64:79], v[232:235], v[224:227], v[64:79]
    ds_read_b128 v[48:51], v13 offset:16384
    ds_read_b64_tr_b16 v[56:57], v14 offset:28672
    v_mfma_f32_32x32x16_bf16 v[80:95], v[236:239], v[224:227], v[80:95]
    ds_read_b64_tr_b16 v[58:59], v14 offset:29696
    ds_read_b64_tr_b16 v[60:61], v15 offset:28672
    v_mfma_f32_32x32x16_bf16 v[96:111], v[232:235], v[228:231], v[96:111]
    ds_read_b64_tr_b16 v[62:63], v15 offset:29696
    ds_read_b128 v[52:55], v13 offset:20480
    v_mfma_f32_32x32x16_bf16 v[112:127], v[236:239], v[228:231], v[112:127]
    s_waitcnt lgkmcnt(6)
    v_mfma_f32_32x32x16_bf16 v[64:79], v[40:43], v[32:35], v[64:79]
    v_mfma_f32_32x32x16_bf16 v[80:95], v[44:47], v[32:35], v[80:95]
    v_mfma_f32_32x32x16_bf16 v[96:111], v[40:43], v[36:39], v[96:111]
    v_mfma_f32_32x32x16_bf16 v[112:127], v[44:47], v[36:39], v[112:127]
    s_waitcnt lgkmcnt(0)
    v_mfma_f32_32x32x16_bf16 v[64:79], v[56:59], v[48:51], v[64:79]
    v_mfma_f32_32x32x16_bf16 v[80:95], v[60:63], v[48:51], v[80:95]
    v_mfma_f32_32x32x16_bf16 v[96:111], v[56:59], v[52:55], v[96:111]
    v_mfma_f32_32x32x16_bf16 v[112:127], v[60:63], v[52:55], v[112:127]
    s_cmp_lg_u32 s13, 0
    s_cbranch_scc1 L_go21
    s_cmp_lg_u32 s82, 0
    s_cbranch_scc1 L_go21
    s_mov_b32 s43, 0
    s_branch L_mc23
L_mp22:
    s_sleep 4
    buffer_load_dwordx2 v[244:245], v21, s[56:59], 0 offen sc1
    s_add_u32 s43, s43, 1
L_mc23:
    s_waitcnt vmcnt(0)
    v_min_u32 v246, v244, v245
    s_nop 0
    v_readfirstlane_b32 s42, v246
    s_nop 3
    s_lshr_b32 s65, s43, 16
    s_or_b32 s42, s42, s65
    s_cmp_eq_u32 s42, 0
    s_cbranch_scc1 L_mp22
L_mx24:
    s_lshl_b32 s42, s2, 7
    s_add_u32 s42, s42, 0x210024
    v_mov_b32 v241, 1
    s_mov_b64 exec, 1
    buffer_store_dword v241, v21, s[52:55], s42 offen sc1
    s_mov_b64 exec, -1
L_go21:
    s_mov_b32 s66, 0x3fb8aa3b
    s_mov_b32 s67, 0x3fb8aa3b
    v_mov_b32 v16, 0xb5c1a2a0
    v_mov_b32 v17, 0xb5c1a2a0
    s_lshr_b32 s42, s13, 1
    s_and_b32 s43, s13, 1
    s_lshl_b32 s63, s8, 2
    s_lshl_b32 s42, s42, 1
    s_add_u32 s63, s63, s42
    s_lshl_b32 s63, s63, 5
    s_lshl_b32 s42, s14, 3
    s_add_u32 s63, s63, s42
    s_lshl_b32 s43, s43, 1
    s_add_u32 s63, s63, s43
    s_lshl_b32 s63, s63, 10
    s_add_u32 s63, s63, 0x1000
    v_lshlrev_b32 v18, 4, v2
    v_pk_fma_f32 v[128:129], v[64:65], s[66:67], v[16:17]
    v_pk_fma_f32 v[130:131], v[66:67], s[66:67], v[16:17]
    v_pk_fma_f32 v[132:133], v[68:69], s[66:67], v[16:17]
    v_pk_fma_f32 v[134:135], v[70:71], s[66:67], v[16:17]
    v_pk_fma_f32 v[136:137], v[72:73], s[66:67], v[16:17]
    v_pk_fma_f32 v[138:139], v[74:75], s[66:67], v[16:17]
    v_pk_fma_f32 v[140:141], v[76:77], s[66:67], v[16:17]
    v_pk_fma_f32 v[142:143], v[78:79], s[66:67], v[16:17]
    v_exp_f32 v128, v128 clamp
    v_max_f32 v64, s64, v64
    v_exp_f32 v129, v129 clamp
    v_max_f32 v65, s64, v65
    v_exp_f32 v130, v130 clamp
    v_max_f32 v66, s64, v66
    v_exp_f32 v131, v131 clamp
    v_max_f32 v67, s64, v67
    v_exp_f32 v132, v132 clamp
    v_max_f32 v68, s64, v68
    v_exp_f32 v133, v133 clamp
    v_max_f32 v69, s64, v69
    v_exp_f32 v134, v134 clamp
    v_max_f32 v70, s64, v70
    v_exp_f32 v135, v135 clamp
    v_max_f32 v71, s64, v71
    v_exp_f32 v136, v136 clamp
    v_max_f32 v72, s64, v72
    v_exp_f32 v137, v137 clamp
    v_max_f32 v73, s64, v73
    v_exp_f32 v138, v138 clamp
    v_max_f32 v74, s64, v74
    v_exp_f32 v139, v139 clamp
    v_max_f32 v75, s64, v75
    v_exp_f32 v140, v140 clamp
    v_max_f32 v76, s64, v76
    v_exp_f32 v141, v141 clamp
    v_max_f32 v77, s64, v77
    v_exp_f32 v142, v142 clamp
    v_max_f32 v78, s64, v78
    v_exp_f32 v143, v143 clamp
    v_max_f32 v79, s64, v79
    v_pk_add_f32 v[64:65], v[64:65], v[128:129]
    v_pk_add_f32 v[66:67], v[66:67], v[130:131]
    v_pk_add_f32 v[68:69], v[68:69], v[132:133]
    v_pk_add_f32 v[70:71], v[70:71], v[134:135]
    v_pk_add_f32 v[72:73], v[72:73], v[136:137]
    v_pk_add_f32 v[74:75], v[74:75], v[138:139]
    v_pk_add_f32 v[76:77], v[76:77], v[140:141]
    v_pk_add_f32 v[78:79], v[78:79], v[142:143]
    v_cvt_pk_bf16_f32 v144, v64, v65
    v_cvt_pk_bf16_f32 v145, v66, v67
    v_cvt_pk_bf16_f32 v146, v68, v69
    v_cvt_pk_bf16_f32 v147, v70, v71
    v_cvt_pk_bf16_f32 v148, v72, v73
    v_cvt_pk_bf16_f32 v149, v74, v75
    v_cvt_pk_bf16_f32 v150, v76, v77
    v_cvt_pk_bf16_f32 v151, v78, v79
    s_add_u32 s65, s63, 0
    buffer_store_dwordx4 v[144:147], v18, s[52:55], s65 offen sc1
    buffer_store_dwordx4 v[148:151], v18, s[52:55], s65 offen offset:1024 sc1
    v_pk_fma_f32 v[128:129], v[80:81], s[66:67], v[16:17]
    v_pk_fma_f32 v[130:131], v[82:83], s[66:67], v[16:17]
    v_pk_fma_f32 v[132:133], v[84:85], s[66:67], v[16:17]
    v_pk_fma_f32 v[134:135], v[86:87], s[66:67], v[16:17]
    v_pk_fma_f32 v[136:137], v[88:89], s[66:67], v[16:17]
    v_pk_fma_f32 v[138:139], v[90:91], s[66:67], v[16:17]
    v_pk_fma_f32 v[140:141], v[92:93], s[66:67], v[16:17]
    v_pk_fma_f32 v[142:143], v[94:95], s[66:67], v[16:17]
    v_exp_f32 v128, v128 clamp
    v_max_f32 v80, s64, v80
    v_exp_f32 v129, v129 clamp
    v_max_f32 v81, s64, v81
    v_exp_f32 v130, v130 clamp
    v_max_f32 v82, s64, v82
    v_exp_f32 v131, v131 clamp
    v_max_f32 v83, s64, v83
    v_exp_f32 v132, v132 clamp
    v_max_f32 v84, s64, v84
    v_exp_f32 v133, v133 clamp
    v_max_f32 v85, s64, v85
    v_exp_f32 v134, v134 clamp
    v_max_f32 v86, s64, v86
    v_exp_f32 v135, v135 clamp
    v_max_f32 v87, s64, v87
    v_exp_f32 v136, v136 clamp
    v_max_f32 v88, s64, v88
    v_exp_f32 v137, v137 clamp
    v_max_f32 v89, s64, v89
    v_exp_f32 v138, v138 clamp
    v_max_f32 v90, s64, v90
    v_exp_f32 v139, v139 clamp
    v_max_f32 v91, s64, v91
    v_exp_f32 v140, v140 clamp
    v_max_f32 v92, s64, v92
    v_exp_f32 v141, v141 clamp
    v_max_f32 v93, s64, v93
    v_exp_f32 v142, v142 clamp
    v_max_f32 v94, s64, v94
    v_exp_f32 v143, v143 clamp
    v_max_f32 v95, s64, v95
    v_pk_add_f32 v[80:81], v[80:81], v[128:129]
    v_pk_add_f32 v[82:83], v[82:83], v[130:131]
    v_pk_add_f32 v[84:85], v[84:85], v[132:133]
    v_pk_add_f32 v[86:87], v[86:87], v[134:135]
    v_pk_add_f32 v[88:89], v[88:89], v[136:137]
    v_pk_add_f32 v[90:91], v[90:91], v[138:139]
    v_pk_add_f32 v[92:93], v[92:93], v[140:141]
    v_pk_add_f32 v[94:95], v[94:95], v[142:143]
    v_cvt_pk_bf16_f32 v152, v80, v81
    v_cvt_pk_bf16_f32 v153, v82, v83
    v_cvt_pk_bf16_f32 v154, v84, v85
    v_cvt_pk_bf16_f32 v155, v86, v87
    v_cvt_pk_bf16_f32 v156, v88, v89
    v_cvt_pk_bf16_f32 v157, v90, v91
    v_cvt_pk_bf16_f32 v158, v92, v93
    v_cvt_pk_bf16_f32 v159, v94, v95
    s_add_u32 s65, s63, 4096
    buffer_store_dwordx4 v[152:155], v18, s[52:55], s65 offen sc1
    buffer_store_dwordx4 v[156:159], v18, s[52:55], s65 offen offset:1024 sc1
    v_pk_fma_f32 v[128:129], v[96:97], s[66:67], v[16:17]
    v_pk_fma_f32 v[130:131], v[98:99], s[66:67], v[16:17]
    v_pk_fma_f32 v[132:133], v[100:101], s[66:67], v[16:17]
    v_pk_fma_f32 v[134:135], v[102:103], s[66:67], v[16:17]
    v_pk_fma_f32 v[136:137], v[104:105], s[66:67], v[16:17]
    v_pk_fma_f32 v[138:139], v[106:107], s[66:67], v[16:17]
    v_pk_fma_f32 v[140:141], v[108:109], s[66:67], v[16:17]
    v_pk_fma_f32 v[142:143], v[110:111], s[66:67], v[16:17]
    v_exp_f32 v128, v128 clamp
    v_max_f32 v96, s64, v96
    v_exp_f32 v129, v129 clamp
    v_max_f32 v97, s64, v97
    v_exp_f32 v130, v130 clamp
    v_max_f32 v98, s64, v98
    v_exp_f32 v131, v131 clamp
    v_max_f32 v99, s64, v99
    v_exp_f32 v132, v132 clamp
    v_max_f32 v100, s64, v100
    v_exp_f32 v133, v133 clamp
    v_max_f32 v101, s64, v101
    v_exp_f32 v134, v134 clamp
    v_max_f32 v102, s64, v102
    v_exp_f32 v135, v135 clamp
    v_max_f32 v103, s64, v103
    v_exp_f32 v136, v136 clamp
    v_max_f32 v104, s64, v104
    v_exp_f32 v137, v137 clamp
    v_max_f32 v105, s64, v105
    v_exp_f32 v138, v138 clamp
    v_max_f32 v106, s64, v106
    v_exp_f32 v139, v139 clamp
    v_max_f32 v107, s64, v107
    v_exp_f32 v140, v140 clamp
    v_max_f32 v108, s64, v108
    v_exp_f32 v141, v141 clamp
    v_max_f32 v109, s64, v109
    v_exp_f32 v142, v142 clamp
    v_max_f32 v110, s64, v110
    v_exp_f32 v143, v143 clamp
    v_max_f32 v111, s64, v111
    v_pk_add_f32 v[96:97], v[96:97], v[128:129]
    v_pk_add_f32 v[98:99], v[98:99], v[130:131]
    v_pk_add_f32 v[100:101], v[100:101], v[132:133]
    v_pk_add_f32 v[102:103], v[102:103], v[134:135]
    v_pk_add_f32 v[104:105], v[104:105], v[136:137]
    v_pk_add_f32 v[106:107], v[106:107], v[138:139]
    v_pk_add_f32 v[108:109], v[108:109], v[140:141]
    v_pk_add_f32 v[110:111], v[110:111], v[142:143]
    v_cvt_pk_bf16_f32 v144, v96, v97
    v_cvt_pk_bf16_f32 v145, v98, v99
    v_cvt_pk_bf16_f32 v146, v100, v101
    v_cvt_pk_bf16_f32 v147, v102, v103
    v_cvt_pk_bf16_f32 v148, v104, v105
    v_cvt_pk_bf16_f32 v149, v106, v107
    v_cvt_pk_bf16_f32 v150, v108, v109
    v_cvt_pk_bf16_f32 v151, v110, v111
    s_add_u32 s65, s63, 32768
    buffer_store_dwordx4 v[144:147], v18, s[52:55], s65 offen sc1
    buffer_store_dwordx4 v[148:151], v18, s[52:55], s65 offen offset:1024 sc1
    v_pk_fma_f32 v[128:129], v[112:113], s[66:67], v[16:17]
    v_pk_fma_f32 v[130:131], v[114:115], s[66:67], v[16:17]
    v_pk_fma_f32 v[132:133], v[116:117], s[66:67], v[16:17]
    v_pk_fma_f32 v[134:135], v[118:119], s[66:67], v[16:17]
    v_pk_fma_f32 v[136:137], v[120:121], s[66:67], v[16:17]
    v_pk_fma_f32 v[138:139], v[122:123], s[66:67], v[16:17]
    v_pk_fma_f32 v[140:141], v[124:125], s[66:67], v[16:17]
    v_pk_fma_f32 v[142:143], v[126:127], s[66:67], v[16:17]
    v_exp_f32 v128, v128 clamp
    v_max_f32 v112, s64, v112
    v_exp_f32 v129, v129 clamp
    v_max_f32 v113, s64, v113
    v_exp_f32 v130, v130 clamp
    v_max_f32 v114, s64, v114
    v_exp_f32 v131, v131 clamp
    v_max_f32 v115, s64, v115
    v_exp_f32 v132, v132 clamp
    v_max_f32 v116, s64, v116
    v_exp_f32 v133, v133 clamp
    v_max_f32 v117, s64, v117
    v_exp_f32 v134, v134 clamp
    v_max_f32 v118, s64, v118
    v_exp_f32 v135, v135 clamp
    v_max_f32 v119, s64, v119
    v_exp_f32 v136, v136 clamp
    v_max_f32 v120, s64, v120
    v_exp_f32 v137, v137 clamp
    v_max_f32 v121, s64, v121
    v_exp_f32 v138, v138 clamp
    v_max_f32 v122, s64, v122
    v_exp_f32 v139, v139 clamp
    v_max_f32 v123, s64, v123
    v_exp_f32 v140, v140 clamp
    v_max_f32 v124, s64, v124
    v_exp_f32 v141, v141 clamp
    v_max_f32 v125, s64, v125
    v_exp_f32 v142, v142 clamp
    v_max_f32 v126, s64, v126
    v_exp_f32 v143, v143 clamp
    v_max_f32 v127, s64, v127
    v_pk_add_f32 v[112:113], v[112:113], v[128:129]
    v_pk_add_f32 v[114:115], v[114:115], v[130:131]
    v_pk_add_f32 v[116:117], v[116:117], v[132:133]
    v_pk_add_f32 v[118:119], v[118:119], v[134:135]
    v_pk_add_f32 v[120:121], v[120:121], v[136:137]
    v_pk_add_f32 v[122:123], v[122:123], v[138:139]
    v_pk_add_f32 v[124:125], v[124:125], v[140:141]
    v_pk_add_f32 v[126:127], v[126:127], v[142:143]
    v_cvt_pk_bf16_f32 v152, v112, v113
    v_cvt_pk_bf16_f32 v153, v114, v115
    v_cvt_pk_bf16_f32 v154, v116, v117
    v_cvt_pk_bf16_f32 v155, v118, v119
    v_cvt_pk_bf16_f32 v156, v120, v121
    v_cvt_pk_bf16_f32 v157, v122, v123
    v_cvt_pk_bf16_f32 v158, v124, v125
    v_cvt_pk_bf16_f32 v159, v126, v127
    s_add_u32 s65, s63, 36864
    buffer_store_dwordx4 v[152:155], v18, s[52:55], s65 offen sc1
    buffer_store_dwordx4 v[156:159], v18, s[52:55], s65 offen offset:1024 sc1
    s_mov_b32 s43, 0
    s_branch L_mc26
L_mp25:
    s_sleep 4
    buffer_load_dwordx2 v[244:245], v21, s[56:59], 0 offen sc1
    s_add_u32 s43, s43, 1
L_mc26:
    s_waitcnt vmcnt(0)
    v_min_u32 v246, v244, v245
    s_nop 0
    v_readfirstlane_b32 s42, v246
    s_nop 3
    s_lshr_b32 s65, s43, 16
    s_or_b32 s42, s42, s65
    s_cmp_eq_u32 s42, 0
    s_cbranch_scc1 L_mp25
L_mx27:
    v_and_b32 v16, 1, v2
    s_lshl_b32 s63, s8, 1
    v_add_u32 v16, s63, v16
    v_lshrrev_b32 v17, 2, v16
    v_and_b32 v16, 3, v16
    v_lshrrev_b32 v18, 1, v2
    v_lshl_add_u32 v16, v18, 2, v16
    v_lshl_add_u32 v17, v16, 3, v17
    v_lshlrev_b32 v17, 7, v17
    s_lshl_b32 s63, s14, 2
    s_add_u32 s63, s63, 0x218000
    s_barrier
    s_cmp_lg_u32 s13, 0
    s_cbranch_scc1 L_sf28
    v_mov_b32 v16, 1
    s_mov_b32 exec_lo, 0xffff
    s_mov_b32 exec_hi, 0x0
    buffer_store_dword v16, v17, s[52:55], s63 offen sc1
    s_mov_b64 exec, -1
L_sf28:
    s_mov_b32 s82, 1
    s_branch L_g2_entry
L_gidle0:
    s_setprio 2
    v_lshrrev_b32 v1, 6, v0
    v_and_b32 v2, 63, v0
    s_nop 0
    v_readfirstlane_b32 s13, v1
    s_waitcnt lgkmcnt(0)
    s_mov_b32 s52, s40
    s_mov_b32 s53, s41
    s_mov_b32 s54, 0x1000000
    s_mov_b32 s55, 0x00020000
    s_mov_b32 s56, s38
    s_mov_b32 s57, s39
    s_mov_b32 s58, 0x100
    s_mov_b32 s59, 0x00020000
    s_sub_u32 s2, s2, 256
    s_mov_b32 s82, 0
    s_mov_b32 s83, s2
L_gidle:
    s_mov_b32 s76, s22
    s_mov_b32 s77, s23
    s_mov_b32 s78, 0x200000
    s_mov_b32 s79, 0x00020000
    s_sub_u32 s8, s83, 192
    s_lshr_b32 s15, s8, 3
    s_lshl_b32 s9, s15, 2
    s_add_u32 s9, s9, s13
    s_and_b32 s8, s8, 7
    s_lshl_b32 s10, s9, 16
    s_lshl_b32 s11, s8, 7
    s_add_u32 s10, s10, s11
    v_lshrrev_b32 v5, 3, v2
    v_and_b32 v6, 7, v2
    v_lshlrev_b32 v7, 13, v5
    v_lshl_add_u32 v7, v6, 4, v7
    v_add_u32 v14, 4096, v7
    v_mov_b32 v4, 0
    buffer_load_dwordx4 v[64:67], v7, s[76:79], s10 offen offset:0
    buffer_load_dwordx4 v[68:71], v7, s[76:79], s10 offen offset:1024
    buffer_load_dwordx4 v[72:75], v7, s[76:79], s10 offen offset:2048
    buffer_load_dwordx4 v[76:79], v7, s[76:79], s10 offen offset:3072
    buffer_load_dwordx4 v[80:83], v14, s[76:79], s10 offen offset:0
    buffer_load_dwordx4 v[84:87], v14, s[76:79], s10 offen offset:1024
    buffer_load_dwordx4 v[88:91], v14, s[76:79], s10 offen offset:2048
    buffer_load_dwordx4 v[92:95], v14, s[76:79], s10 offen offset:3072
    s_cmp_lg_u32 s83, 193
    s_cbranch_scc1 L_gi_nozeroa
    v_lshlrev_b32 v8, 4, v0
    v_mov_b32 v16, 0
    v_mov_b32 v17, 0
    v_mov_b32 v18, 0
    v_mov_b32 v19, 0
    s_add_u32 s72, s40, 0x210000
    s_addc_u32 s73, s41, 0
    s_mov_b32 s74, 0x11000
    s_mov_b32 s75, 0x00020000
    s_mov_b32 s12, 0
    buffer_store_dwordx4 v[16:19], v8, s[72:75], s12 offen sc0 sc1
    s_mov_b32 s12, 4096
    buffer_store_dwordx4 v[16:19], v8, s[72:75], s12 offen sc0 sc1
    s_mov_b32 s12, 8192
    buffer_store_dwordx4 v[16:19], v8, s[72:75], s12 offen sc0 sc1
    s_mov_b32 s12, 12288
    buffer_store_dwordx4 v[16:19], v8, s[72:75], s12 offen sc0 sc1
    s_mov_b32 s12, 16384
    buffer_store_dwordx4 v[16:19], v8, s[72:75], s12 offen sc0 sc1
    s_mov_b32 s12, 20480
    buffer_store_dwordx4 v[16:19], v8, s[72:75], s12 offen sc0 sc1
    s_mov_b32 s12, 24576
    buffer_store_dwordx4 v[16:19], v8, s[72:75], s12 offen sc0 sc1
    s_mov_b32 s12, 28672
    buffer_store_dwordx4 v[16:19], v8, s[72:75], s12 offen sc0 sc1
    s_mov_b32 s12, 32768
    buffer_store_dwordx4 v[16:19], v8, s[72:75], s12 offen sc0 sc1
    s_mov_b32 s12, 36864
    buffer_store_dwordx4 v[16:19], v8, s[72:75], s12 offen sc0 sc1
    s_mov_b32 s12, 40960
    buffer_store_dwordx4 v[16:19], v8, s[72:75], s12 offen sc0 sc1
    s_mov_b32 s12, 45056
    buffer_store_dwordx4 v[16:19], v8, s[72:75], s12 offen sc0 sc1
    s_mov_b32 s12, 49152
    buffer_store_dwordx4 v[16:19], v8, s[72:75], s12 offen sc0 sc1
    s_mov_b32 s12, 53248
    buffer_store_dwordx4 v[16:19], v8, s[72:75], s12 offen sc0 sc1
    s_mov_b32 s12, 57344
    buffer_store_dwordx4 v[16:19], v8, s[72:75], s12 offen sc0 sc1
    s_mov_b32 s12, 61440
    buffer_store_dwordx4 v[16:19], v8, s[72:75], s12 offen sc0 sc1
    s_mov_b32 s12, 65536
    buffer_store_dwordx4 v[16:19], v8, s[72:75], s12 offen sc0 sc1
    s_waitcnt vmcnt(0)
    s_barrier
    s_cmp_lg_u32 s13, 0
    s_cbranch_scc1 L_gi_nozeroa
    v_mov_b32 v8, 1
    s_mov_b64 exec, 1
    buffer_store_dword v8, v4, s[56:59], 0 offen offset:0 sc0 sc1
    s_mov_b64 exec, -1
L_gi_nozeroa:
    s_cmp_lg_u32 s83, 192
    s_cbranch_scc1 L_gi_nozerob
    v_lshlrev_b32 v8, 4, v0
    v_mov_b32 v16, 0
    v_mov_b32 v17, 0
    v_mov_b32 v18, 0
    v_mov_b32 v19, 0
    s_add_u32 s72, s40, 0x230000
    s_addc_u32 s73, s41, 0
    s_mov_b32 s74, 0xb000
    s_mov_b32 s75, 0x00020000
    s_mov_b32 s12, 0
    buffer_store_dwordx4 v[16:19], v8, s[72:75], s12 offen sc0 sc1
    s_mov_b32 s12, 4096
    buffer_store_dwordx4 v[16:19], v8, s[72:75], s12 offen sc0 sc1
    s_mov_b32 s12, 8192
    buffer_store_dwordx4 v[16:19], v8, s[72:75], s12 offen sc0 sc1
    s_mov_b32 s12, 12288
    buffer_store_dwordx4 v[16:19], v8, s[72:75], s12 offen sc0 sc1
    s_mov_b32 s12, 16384
    buffer_store_dwordx4 v[16:19], v8, s[72:75], s12 offen sc0 sc1
    s_mov_b32 s12, 20480
    buffer_store_dwordx4 v[16:19], v8, s[72:75], s12 offen sc0 sc1
    s_mov_b32 s12, 24576
    buffer_store_dwordx4 v[16:19], v8, s[72:75], s12 offen sc0 sc1
    s_mov_b32 s12, 28672
    buffer_store_dwordx4 v[16:19], v8, s[72:75], s12 offen sc0 sc1
    s_mov_b32 s12, 32768
    buffer_store_dwordx4 v[16:19], v8, s[72:75], s12 offen sc0 sc1
    s_mov_b32 s12, 36864
    buffer_store_dwordx4 v[16:19], v8, s[72:75], s12 offen sc0 sc1
    s_mov_b32 s12, 40960
    buffer_store_dwordx4 v[16:19], v8, s[72:75], s12 offen sc0 sc1
    s_waitcnt vmcnt(0)
    s_barrier
    s_cmp_lg_u32 s13, 0
    s_cbranch_scc1 L_gi_nozerob
    v_mov_b32 v8, 1
    s_mov_b64 exec, 1
    buffer_store_dword v8, v4, s[56:59], 0 offen offset:4 sc0 sc1
    s_mov_b64 exec, -1
L_gi_nozerob:
    s_lshl_b32 s12, s13, 13
    v_xor_b32 v8, v5, v6
    v_lshlrev_b32 v8, 4, v8
    v_lshl_add_u32 v8, v6, 10, v8
    v_add_u32 v8, s12, v8
    v_lshlrev_b32 v9, 4, v2
    v_add_u32 v9, s12, v9
    s_mul_i32 s10, s8, 270336
    s_lshl_b32 s11, s9, 7
    s_add_u32 s10, s10, s11
    s_add_u32 s10, s10, 0x600080
    s_movk_i32 s12, 4224
    v_mul_lo_u32 v7, v5, s12
    v_lshl_add_u32 v7, v6, 4, v7
    v_lshlrev_b32 v10, 10, v2
    s_lshl_b32 s14, s8, 7
    s_lshl_b32 s15, s15, 2
    s_add_u32 s14, s14, s15
    s_add_u32 s14, s14, 0x210000
    s_mov_b32 s8, 0x05040100
    s_mov_b32 s9, 0x07060302
    s_waitcnt vmcnt(0)
    v_perm_b32 v96, v68, v64, s8
    v_perm_b32 v97, v76, v72, s8
    v_perm_b32 v98, v84, v80, s8
    v_perm_b32 v99, v92, v88, s8
    ds_write_b128 v8, v[96:99] offset:0
    v_perm_b32 v100, v68, v64, s9
    v_perm_b32 v101, v76, v72, s9
    v_perm_b32 v102, v84, v80, s9
    v_perm_b32 v103, v92, v88, s9
    ds_write_b128 v8, v[100:103] offset:128
    v_perm_b32 v104, v69, v65, s8
    v_perm_b32 v105, v77, v73, s8
    v_perm_b32 v106, v85, v81, s8
    v_perm_b32 v107, v93, v89, s8
    ds_write_b128 v8, v[104:107] offset:256
    v_perm_b32 v108, v69, v65, s9
    v_perm_b32 v109, v77, v73, s9
    v_perm_b32 v110, v85, v81, s9
    v_perm_b32 v111, v93, v89, s9
    ds_write_b128 v8, v[108:111] offset:384
    v_perm_b32 v112, v70, v66, s8
    v_perm_b32 v113, v78, v74, s8
    v_perm_b32 v114, v86, v82, s8
    v_perm_b32 v115, v94, v90, s8
    ds_write_b128 v8, v[112:115] offset:512
    v_perm_b32 v116, v70, v66, s9
    v_perm_b32 v117, v78, v74, s9
    v_perm_b32 v118, v86, v82, s9
    v_perm_b32 v119, v94, v90, s9
    ds_write_b128 v8, v[116:119] offset:640
    v_perm_b32 v120, v71, v67, s8
    v_perm_b32 v121, v79, v75, s8
    v_perm_b32 v122, v87, v83, s8
    v_perm_b32 v123, v95, v91, s8
    ds_write_b128 v8, v[120:123] offset:768
    v_perm_b32 v124, v71, v67, s9
    v_perm_b32 v125, v79, v75, s9
    v_perm_b32 v126, v87, v83, s9
    v_perm_b32 v127, v95, v91, s9
    ds_write_b128 v8, v[124:127] offset:896
    buffer_load_dwordx2 v[244:245], v4, s[56:59], 0 offen sc1
    s_waitcnt lgkmcnt(0)
    v_xor_b32 v11, 0, v9
    ds_read_b128 v[64:67], v11 offset:0
    v_xor_b32 v11, 16, v9
    ds_read_b128 v[68:71], v11 offset:1024
    v_xor_b32 v11, 32, v9
    ds_read_b128 v[72:75], v11 offset:2048
    v_xor_b32 v11, 48, v9
    ds_read_b128 v[76:79], v11 offset:3072
    v_xor_b32 v11, 64, v9
    ds_read_b128 v[80:83], v11 offset:4096
    v_xor_b32 v11, 80, v9
    ds_read_b128 v[84:87], v11 offset:5120
    v_xor_b32 v11, 96, v9
    ds_read_b128 v[88:91], v11 offset:6144
    v_xor_b32 v11, 112, v9
    ds_read_b128 v[92:95], v11 offset:7168
    s_waitcnt lgkmcnt(7)
    s_add_u32 s11, s10, 0
    buffer_store_dwordx4 v[64:67], v7, s[52:55], s11 offen sc1
    s_waitcnt lgkmcnt(6)
    s_add_u32 s11, s10, 33792
    buffer_store_dwordx4 v[68:71], v7, s[52:55], s11 offen sc1
    s_waitcnt lgkmcnt(5)
    s_add_u32 s11, s10, 67584
    buffer_store_dwordx4 v[72:75], v7, s[52:55], s11 offen sc1
    s_waitcnt lgkmcnt(4)
    s_add_u32 s11, s10, 101376
    buffer_store_dwordx4 v[76:79], v7, s[52:55], s11 offen sc1
    s_waitcnt lgkmcnt(3)
    s_add_u32 s11, s10, 135168
    buffer_store_dwordx4 v[80:83], v7, s[52:55], s11 offen sc1
    s_waitcnt lgkmcnt(2)
    s_add_u32 s11, s10, 168960
    buffer_store_dwordx4 v[84:87], v7, s[52:55], s11 offen sc1
    s_waitcnt lgkmcnt(1)
    s_add_u32 s11, s10, 202752
    buffer_store_dwordx4 v[88:91], v7, s[52:55], s11 offen sc1
    s_waitcnt lgkmcnt(0)
    s_add_u32 s11, s10, 236544
    buffer_store_dwordx4 v[92:95], v7, s[52:55], s11 offen sc1
    s_mov_b32 s43, 0
    s_branch L_mc30
L_mp29:
    s_sleep 4
    buffer_load_dwordx2 v[244:245], v4, s[56:59], 0 offen sc1
    s_add_u32 s43, s43, 1
L_mc30:
    s_waitcnt vmcnt(0)
    v_min_u32 v246, v244, v245
    s_nop 0
    v_readfirstlane_b32 s42, v246
    s_nop 3
    s_lshr_b32 s65, s43, 16
    s_or_b32 s42, s42, s65
    s_cmp_eq_u32 s42, 0
    s_cbranch_scc1 L_mp29
L_mx31:
    s_barrier
    s_cmp_lg_u32 s13, 0
    s_cbranch_scc1 L_sf32
    v_mov_b32 v16, 1
    s_mov_b32 exec_lo, 0xffffffff
    s_mov_b32 exec_hi, 0x0
    buffer_store_dword v16, v10, s[52:55], s14 offen sc1
    s_mov_b64 exec, -1
L_sf32:
    s_cmp_lg_u32 s13, 0
    s_cbranch_scc1 L_go33
    s_cmp_lg_u32 s82, 0
    s_cbranch_scc1 L_go33
    s_mov_b32 s43, 0
    s_branch L_mc35
L_mp34:
    s_sleep 4
    buffer_load_dwordx2 v[244:245], v4, s[56:59], 0 offen sc1
    s_add_u32 s43, s43, 1
L_mc35:
    s_waitcnt vmcnt(0)
    v_min_u32 v246, v244, v245
    s_nop 0
    v_readfirstlane_b32 s42, v246
    s_nop 3
    s_lshr_b32 s65, s43, 16
    s_or_b32 s42, s42, s65
    s_cmp_eq_u32 s42, 0
    s_cbranch_scc1 L_mp34
L_mx36:
    s_lshl_b32 s42, s2, 7
    s_add_u32 s42, s42, 0x210024
    v_mov_b32 v241, 1
    s_mov_b64 exec, 1
    buffer_store_dword v241, v4, s[52:55], s42 offen sc1
    s_mov_b64 exec, -1
L_go33:
    s_mov_b32 s82, 1
    s_mov_b32 s72, s20
    s_mov_b32 s73, s21
    s_mov_b32 s74, 0x80000
    s_mov_b32 s75, 0x00020000
    s_sub_u32 s42, s83, 192
    s_lshr_b32 s42, s42, 3
    s_lshl_b32 s42, s42, 16
    v_lshlrev_b32 v16, 7, v0
    buffer_load_dword v64, v16, s[72:75], s42 offen
    s_add_u32 s42, s42, 32768
    buffer_load_dword v65, v16, s[72:75], s42 offen
    s_add_u32 s42, s42, 32768
    s_branch L_g2_entry
L_exit:
    s_endpgm
L_code_end:
.section .rodata,"a"
.p2align 6
.amdhsa_kernel concat_heads__linear_attn_block__ssm_conv_s4d__prompt_kernel
  .amdhsa_next_free_vgpr 256
  .amdhsa_next_free_sgpr 96
  .amdhsa_accum_offset 256
  .amdhsa_group_segment_fixed_size 0
  .amdhsa_kernarg_size 104
  .amdhsa_user_sgpr_count 2
  .amdhsa_user_sgpr_kernarg_segment_ptr 1
  .amdhsa_system_sgpr_workgroup_id_x 1
.end_amdhsa_kernel
```
